```python
import torch

def _softmax(x, axis=-1):
    return torch.softmax(x, dim=axis)
def _gelu(x):
    return torch.nn.functional.gelu(x, approximate="tanh")
def _silu(x):
    return torch.nn.functional.silu(x)
def _sigmoid(x):
    return torch.sigmoid(x)
def _layernorm(x, axis=-1, eps=1e-5):
    m = x.mean(dim=axis, keepdim=True)
    v = x.var(dim=axis, keepdim=True, unbiased=False)
    return (x - m) / torch.sqrt(v + eps)
def _scatter_add(tgt, idx, src, axis=0):
    return tgt.clone().index_add_(axis, idx, src)
def _segment_sum(src, seg, n):
    out = torch.zeros((n,) + src.shape[1:], dtype=src.dtype)
    return out.index_add_(0, seg, src)
def _pad(x, pw):
    flat = tuple(v for pair in reversed(pw) for v in pair)
    return torch.nn.functional.pad(x, flat)

kernel_name = 'standalone__low_rank_proj_linformer__sampling'

def setup_inputs():

    _w = (lambda a: (lambda t: t.to(torch.bfloat16) if t.is_floating_point() else t)(torch.as_tensor(a)))
    B, H, Sq, Skv, Dh, R = 16, 32, 4, 4096, 128, 16
    return {
        "q": _w((lambda *s: torch.randn(*s, dtype=torch.bfloat16) * 0.8)(B, H, Sq, Dh)),
        "k": _w((lambda *s: torch.randn(*s, dtype=torch.bfloat16) * 0.8)(B, H, Skv, Dh)),
        "v": _w((lambda *s: torch.randn(*s, dtype=torch.bfloat16) * 0.05)(B, H, Skv, Dh)),
        "e_proj": _w((lambda *s: torch.randn(*s, dtype=torch.bfloat16) * 0.8)(R, Skv) * (Skv ** -0.5)),
        "f_proj": _w((lambda *s: torch.randn(*s, dtype=torch.bfloat16) * 0.05)(R, Skv) * (Skv ** -0.5)),
    }

def reference(q, k, v, e_proj, f_proj):
    B, H, Sq, Dh = q.shape
    kp = torch.einsum("rn,bhnd->bhrd", e_proj, k)
    vp = torch.einsum("rn,bhnd->bhrd", f_proj, v)
    scores = torch.einsum("bhqd,bhrd->bhqr", q, kp) * (Dh ** -0.5)
    p = _softmax(scores, axis=-1)
    o = torch.einsum("bhqr,bhrd->bhqd", p, vp)
    return o
```

```asm
; @launch grid=(256,1,1) block=(128,1,1) lds=98304
.amdgcn_target "amdgcn-amd-amdhsa--gfx950"
.text
.globl standalone__low_rank_proj_linformer__sampling_kernel
.p2align 8
.type standalone__low_rank_proj_linformer__sampling_kernel,@function
standalone__low_rank_proj_linformer__sampling_kernel:
    s_load_dwordx8 s[4:11], s[0:1], 0
    s_load_dwordx8 s[12:19], s[0:1], 32
    s_cmp_ge_u32 s2, 256
    s_cbranch_scc1 L_end
    v_readfirstlane_b32 s37, v0
    v_and_b32 v5, 15, v0
    v_bfe_u32 v4, v0, 4, 1
    v_bfe_u32 v7, v0, 5, 1
    v_lshlrev_b32 v1, 4, v5
    v_lshl_add_u32 v1, v4, 13, v1
    v_lshl_add_u32 v1, v7, 16, v1
    v_add_u32 v2, 0x1000, v1
    s_and_b32 s30, s2, 1
    s_lshr_b32 s3, s2, 1
    s_lshl_b32 s3, s3, 2
    s_or_b32 s30, s30, s3
    s_lshl_b32 s42, s30, 20
    s_mov_b32 s34, 0
    s_and_b32 s3, s34, 3
    s_lshl_b32 s3, s3, 14
    s_lshr_b32 s32, s34, 2
    s_lshl_b32 s32, s32, 17
    s_or_b32 s32, s32, s3
    s_lshr_b32 s33, s32, 7
    s_mov_b32 s26, 1048576
    s_mov_b32 s27, 0x20000
    s_cmp_lg_u32 s37, 0
    s_waitcnt lgkmcnt(0)
    s_cbranch_scc1 L_helper
    s_add_u32 s24, s6, s42
    s_addc_u32 s25, s7, 0
    buffer_load_dwordx4 v[104:107], v1, s[24:27], s32 offen offset:0 nt
    buffer_load_dwordx4 v[108:111], v1, s[24:27], s32 offen offset:256 nt
    buffer_load_dwordx4 v[112:115], v1, s[24:27], s32 offen offset:512 nt
    buffer_load_dwordx4 v[116:119], v1, s[24:27], s32 offen offset:768 nt
    v_lshlrev_b32 v3, 13, v5
    v_lshl_add_u32 v3, v4, 6, v3
    v_lshl_add_u32 v3, v7, 9, v3
    s_mov_b32 s20, s10
    s_mov_b32 s21, s11
    s_mov_b32 s22, 131072
    s_mov_b32 s23, 0x20000
    buffer_load_dwordx4 v[72:75], v3, s[20:23], s33 offen offset:0
    buffer_load_dwordx4 v[76:79], v3, s[20:23], s33 offen offset:16
    buffer_load_dwordx4 v[80:83], v3, s[20:23], s33 offen offset:32
    buffer_load_dwordx4 v[84:87], v3, s[20:23], s33 offen offset:48
    buffer_load_dwordx4 v[120:123], v1, s[24:27], s32 offen offset:1024 nt
    buffer_load_dwordx4 v[124:127], v1, s[24:27], s32 offen offset:1280 nt
    buffer_load_dwordx4 v[128:131], v1, s[24:27], s32 offen offset:1536 nt
    buffer_load_dwordx4 v[132:135], v1, s[24:27], s32 offen offset:1792 nt
    buffer_load_dwordx4 v[136:139], v1, s[24:27], s32 offen offset:2048 nt
    buffer_load_dwordx4 v[140:143], v1, s[24:27], s32 offen offset:2304 nt
    buffer_load_dwordx4 v[144:147], v1, s[24:27], s32 offen offset:2560 nt
    buffer_load_dwordx4 v[148:151], v1, s[24:27], s32 offen offset:2816 nt
    buffer_load_dwordx4 v[152:155], v1, s[24:27], s32 offen offset:3072 nt
    buffer_load_dwordx4 v[156:159], v1, s[24:27], s32 offen offset:3328 nt
    buffer_load_dwordx4 v[160:163], v1, s[24:27], s32 offen offset:3584 nt
    buffer_load_dwordx4 v[164:167], v1, s[24:27], s32 offen offset:3840 nt
    buffer_load_dwordx4 v[168:171], v2, s[24:27], s32 offen offset:0 nt
    buffer_load_dwordx4 v[172:175], v2, s[24:27], s32 offen offset:256 nt
    buffer_load_dwordx4 v[176:179], v2, s[24:27], s32 offen offset:512 nt
    buffer_load_dwordx4 v[180:183], v2, s[24:27], s32 offen offset:768 nt
    buffer_load_dwordx4 v[184:187], v2, s[24:27], s32 offen offset:1024 nt
    buffer_load_dwordx4 v[188:191], v2, s[24:27], s32 offen offset:1280 nt
    buffer_load_dwordx4 v[192:195], v2, s[24:27], s32 offen offset:1536 nt
    buffer_load_dwordx4 v[196:199], v2, s[24:27], s32 offen offset:1792 nt
    buffer_load_dwordx4 v[200:203], v2, s[24:27], s32 offen offset:2048 nt
    buffer_load_dwordx4 v[204:207], v2, s[24:27], s32 offen offset:2304 nt
    buffer_load_dwordx4 v[208:211], v2, s[24:27], s32 offen offset:2560 nt
    buffer_load_dwordx4 v[212:215], v2, s[24:27], s32 offen offset:2816 nt
    buffer_load_dwordx4 v[216:219], v2, s[24:27], s32 offen offset:3072 nt
    buffer_load_dwordx4 v[220:223], v2, s[24:27], s32 offen offset:3328 nt
    buffer_load_dwordx4 v[224:227], v2, s[24:27], s32 offen offset:3584 nt
    buffer_load_dwordx4 v[228:231], v2, s[24:27], s32 offen offset:3840 nt
    s_add_u32 s28, s8, s42
    s_addc_u32 s29, s9, 0
    s_lshl_b32 s43, s30, 10
    s_add_u32 s43, s43, 2048
    s_add_u32 s44, s14, s43
    s_addc_u32 s45, s15, 0
    s_mov_b32 s46, 1024
    s_mov_b32 s47, 0x20000
    s_mov_b32 s35, 0x05040100
    s_mov_b32 s36, 0x07060302
    s_mov_b32 s51, 0
    s_mov_b32 s39, 0
    s_mov_b32 s41, 0
    s_mov_b32 s86, 0
    s_mov_b32 s87, 0
    s_mov_b32 s38, 15
    v_lshlrev_b32 v6, 4, v0
    s_mov_b64 s[78:79], s[16:17]
    s_mov_b64 s[96:97], s[16:17]
    s_mov_b32 s98, 0
    s_mov_b32 s99, 0x20000
    s_mov_b32 s94, 0x400010
    s_mov_b32 s95, 0x400100
    s_mov_b32 s82, 0
    s_mov_b32 s83, -1
    s_mov_b32 s84, 0
    v_mov_b32 v232, 0
    v_lshlrev_b32 v233, 2, v0
    s_mov_b32 s88, 0
    s_mov_b32 s100, 0x100004
    s_mov_b32 s101, 0x100040
    s_mov_b32 s76, 0
    s_mov_b32 s77, 0
    s_mov_b32 s40, 0
    s_cmp_lt_u32 s2, 8
    s_cselect_b32 s90, 0x100004, 0
    s_cselect_b32 s91, 0x100040, 0
    v_mov_b64 v[40:41], 0
    v_mov_b64 v[42:43], 0
    v_mov_b64 v[44:45], 0
    v_mov_b64 v[46:47], 0
    v_mov_b64 v[48:49], 0
    v_mov_b64 v[50:51], 0
    v_mov_b64 v[52:53], 0
    v_mov_b64 v[54:55], 0
    v_mov_b64 v[56:57], 0
    v_mov_b64 v[58:59], 0
    v_mov_b64 v[60:61], 0
    v_mov_b64 v[62:63], 0
    v_mov_b64 v[64:65], 0
    v_mov_b64 v[66:67], 0
    v_mov_b64 v[68:69], 0
    v_mov_b64 v[70:71], 0
    s_waitcnt vmcnt(28)
    .p2align 3
L_k1:
    s_add_u32 s34, s34, 1
    s_and_b32 s34, s34, 31
    s_and_b32 s3, s34, 3
    s_lshl_b32 s3, s3, 14
    s_lshr_b32 s32, s34, 2
    s_lshl_b32 s32, s32, 17
    s_or_b32 s32, s32, s3
    s_lshr_b32 s33, s32, 7
    s_add_u32 s39, s39, 1
    s_cmp_lg_u32 s39, 32
    s_cbranch_scc1 L_adv1
    s_add_u32 s24, s24, 2097152
    s_addc_u32 s25, s25, 0
    s_cmp_eq_u32 s51, 1
    s_cselect_b64 s[24:25], s[28:29], s[24:25]
    s_cselect_b64 s[20:21], s[12:13], s[20:21]
    s_mov_b32 s39, 0
    s_add_u32 s51, s51, 1
    s_cmp_ge_u32 s51, 4
    s_cselect_b32 s26, 0, s26
    s_cselect_b32 s22, 0, s22
L_adv1:
    s_waitcnt vmcnt(30)
    v_perm_b32 v8, v108, v104, s35
    v_perm_b32 v12, v108, v104, s36
    v_perm_b32 v16, v109, v105, s35
    v_perm_b32 v20, v109, v105, s36
    v_perm_b32 v24, v110, v106, s35
    v_perm_b32 v28, v110, v106, s36
    v_perm_b32 v32, v111, v107, s35
    v_perm_b32 v36, v111, v107, s36
    s_waitcnt vmcnt(19)
    buffer_load_dwordx4 v[88:91], v3, s[20:23], s33 offen offset:0
    buffer_load_dwordx4 v[92:95], v3, s[20:23], s33 offen offset:16
    buffer_load_dwordx4 v[96:99], v3, s[20:23], s33 offen offset:32
    buffer_load_dwordx4 v[100:103], v3, s[20:23], s33 offen offset:48
    buffer_load_dword v232, v233, s[96:99], 0 offen sc1
    buffer_load_dwordx4 v[104:107], v1, s[24:27], s32 offen offset:0 nt
    buffer_load_dwordx4 v[108:111], v1, s[24:27], s32 offen offset:256 nt
    s_cmp_lg_u32 s86, 1
    s_cbranch_scc1 L_nd2
    ds_write_b128 v4, v[40:43] offset:0
    ds_write_b128 v4, v[44:47] offset:1024
    ds_write_b128 v4, v[48:51] offset:2048
    ds_write_b128 v4, v[52:55] offset:3072
L_nd2:
    v_perm_b32 v9, v116, v112, s35
    v_perm_b32 v13, v116, v112, s36
    v_perm_b32 v17, v117, v113, s35
    v_perm_b32 v21, v117, v113, s36
    v_perm_b32 v25, v118, v114, s35
    v_perm_b32 v29, v118, v114, s36
    v_perm_b32 v33, v119, v115, s35
    v_perm_b32 v37, v119, v115, s36
    s_waitcnt vmcnt(24)
    buffer_load_dwordx4 v[112:115], v1, s[24:27], s32 offen offset:512 nt
    buffer_load_dwordx4 v[116:119], v1, s[24:27], s32 offen offset:768 nt
    s_cmp_lg_u32 s86, 1
    s_cbranch_scc1 L_nd3
    ds_write_b128 v4, v[56:59] offset:4096
    ds_write_b128 v4, v[60:63] offset:5120
    ds_write_b128 v4, v[64:67] offset:6144
    ds_write_b128 v4, v[68:71] offset:7168
    v_mov_b64 v[40:41], 0
    v_mov_b64 v[42:43], 0
    v_mov_b64 v[44:45], 0
    v_mov_b64 v[46:47], 0
    v_mov_b64 v[48:49], 0
    v_mov_b64 v[50:51], 0
    v_mov_b64 v[52:53], 0
    v_mov_b64 v[54:55], 0
L_nd3:
    v_perm_b32 v10, v124, v120, s35
    v_perm_b32 v14, v124, v120, s36
    v_perm_b32 v18, v125, v121, s35
    v_perm_b32 v22, v125, v121, s36
    v_perm_b32 v26, v126, v122, s35
    v_perm_b32 v30, v126, v122, s36
    v_perm_b32 v34, v127, v123, s35
    v_perm_b32 v38, v127, v123, s36
    s_waitcnt vmcnt(24)
    buffer_load_dwordx4 v[120:123], v1, s[24:27], s32 offen offset:1024 nt
    buffer_load_dwordx4 v[124:127], v1, s[24:27], s32 offen offset:1280 nt
    s_cmp_lg_u32 s86, 1
    s_cbranch_scc1 L_nd4
    v_mov_b64 v[56:57], 0
    v_mov_b64 v[58:59], 0
    v_mov_b64 v[60:61], 0
    v_mov_b64 v[62:63], 0
    v_mov_b64 v[64:65], 0
    v_mov_b64 v[66:67], 0
    v_mov_b64 v[68:69], 0
    v_mov_b64 v[70:71], 0
L_nd4:
    v_perm_b32 v11, v132, v128, s35
    v_perm_b32 v15, v132, v128, s36
    v_perm_b32 v19, v133, v129, s35
    v_mfma_f32_16x16x32_bf16 v[40:43], v[8:11], v[72:75], v[40:43]
    v_perm_b32 v23, v133, v129, s36
    v_perm_b32 v27, v134, v130, s35
    v_mfma_f32_16x16x32_bf16 v[44:47], v[12:15], v[72:75], v[44:47]
    v_perm_b32 v31, v134, v130, s36
    v_perm_b32 v35, v135, v131, s35
    v_mfma_f32_16x16x32_bf16 v[48:51], v[16:19], v[72:75], v[48:51]
    v_perm_b32 v39, v135, v131, s36
    v_mfma_f32_16x16x32_bf16 v[52:55], v[20:23], v[72:75], v[52:55]
    s_waitcnt vmcnt(24)
    buffer_load_dwordx4 v[128:131], v1, s[24:27], s32 offen offset:1536 nt
    buffer_load_dwordx4 v[132:135], v1, s[24:27], s32 offen offset:1792 nt
    v_mfma_f32_16x16x32_bf16 v[56:59], v[24:27], v[72:75], v[56:59]
    v_perm_b32 v8, v140, v136, s35
    v_perm_b32 v12, v140, v136, s36
    v_mfma_f32_16x16x32_bf16 v[60:63], v[28:31], v[72:75], v[60:63]
    v_perm_b32 v16, v141, v137, s35
    v_perm_b32 v20, v141, v137, s36
    v_mfma_f32_16x16x32_bf16 v[64:67], v[32:35], v[72:75], v[64:67]
    v_perm_b32 v24, v142, v138, s35
    v_perm_b32 v28, v142, v138, s36
    v_mfma_f32_16x16x32_bf16 v[68:71], v[36:39], v[72:75], v[68:71]
    v_perm_b32 v32, v143, v139, s35
    v_perm_b32 v36, v143, v139, s36
    s_waitcnt vmcnt(24)
    buffer_load_dwordx4 v[136:139], v1, s[24:27], s32 offen offset:2048 nt
    buffer_load_dwordx4 v[140:143], v1, s[24:27], s32 offen offset:2304 nt
    v_perm_b32 v9, v148, v144, s35
    v_perm_b32 v13, v148, v144, s36
    v_perm_b32 v17, v149, v145, s35
    v_perm_b32 v21, v149, v145, s36
    v_perm_b32 v25, v150, v146, s35
    v_perm_b32 v29, v150, v146, s36
    v_perm_b32 v33, v151, v147, s35
    v_perm_b32 v37, v151, v147, s36
    s_waitcnt vmcnt(24)
    buffer_load_dwordx4 v[144:147], v1, s[24:27], s32 offen offset:2560 nt
    buffer_load_dwordx4 v[148:151], v1, s[24:27], s32 offen offset:2816 nt
    v_perm_b32 v10, v156, v152, s35
    v_perm_b32 v14, v156, v152, s36
    v_perm_b32 v18, v157, v153, s35
    v_perm_b32 v22, v157, v153, s36
    v_perm_b32 v26, v158, v154, s35
    v_perm_b32 v30, v158, v154, s36
    v_perm_b32 v34, v159, v155, s35
    v_perm_b32 v38, v159, v155, s36
    s_waitcnt vmcnt(24)
    buffer_load_dwordx4 v[152:155], v1, s[24:27], s32 offen offset:3072 nt
    buffer_load_dwordx4 v[156:159], v1, s[24:27], s32 offen offset:3328 nt
    v_perm_b32 v11, v164, v160, s35
    v_perm_b32 v15, v164, v160, s36
    v_perm_b32 v19, v165, v161, s35
    v_mfma_f32_16x16x32_bf16 v[40:43], v[8:11], v[76:79], v[40:43]
    v_perm_b32 v23, v165, v161, s36
    v_perm_b32 v27, v166, v162, s35
    v_mfma_f32_16x16x32_bf16 v[44:47], v[12:15], v[76:79], v[44:47]
    v_perm_b32 v31, v166, v162, s36
    v_perm_b32 v35, v167, v163, s35
    v_mfma_f32_16x16x32_bf16 v[48:51], v[16:19], v[76:79], v[48:51]
    v_perm_b32 v39, v167, v163, s36
    v_mfma_f32_16x16x32_bf16 v[52:55], v[20:23], v[76:79], v[52:55]
    s_waitcnt vmcnt(24)
    buffer_load_dwordx4 v[160:163], v1, s[24:27], s32 offen offset:3584 nt
    buffer_load_dwordx4 v[164:167], v1, s[24:27], s32 offen offset:3840 nt
    v_mfma_f32_16x16x32_bf16 v[56:59], v[24:27], v[76:79], v[56:59]
    v_perm_b32 v8, v172, v168, s35
    v_perm_b32 v12, v172, v168, s36
    v_mfma_f32_16x16x32_bf16 v[60:63], v[28:31], v[76:79], v[60:63]
    v_perm_b32 v16, v173, v169, s35
    v_perm_b32 v20, v173, v169, s36
    v_mfma_f32_16x16x32_bf16 v[64:67], v[32:35], v[76:79], v[64:67]
    v_perm_b32 v24, v174, v170, s35
    v_perm_b32 v28, v174, v170, s36
    v_mfma_f32_16x16x32_bf16 v[68:71], v[36:39], v[76:79], v[68:71]
    v_perm_b32 v32, v175, v171, s35
    v_perm_b32 v36, v175, v171, s36
    s_waitcnt vmcnt(24)
    buffer_load_dwordx4 v[168:171], v2, s[24:27], s32 offen offset:0 nt
    buffer_load_dwordx4 v[172:175], v2, s[24:27], s32 offen offset:256 nt
    v_perm_b32 v9, v180, v176, s35
    v_perm_b32 v13, v180, v176, s36
    v_perm_b32 v17, v181, v177, s35
    v_perm_b32 v21, v181, v177, s36
    v_perm_b32 v25, v182, v178, s35
    v_perm_b32 v29, v182, v178, s36
    v_perm_b32 v33, v183, v179, s35
    v_perm_b32 v37, v183, v179, s36
    s_waitcnt vmcnt(24)
    buffer_load_dwordx4 v[176:179], v2, s[24:27], s32 offen offset:512 nt
    buffer_load_dwordx4 v[180:183], v2, s[24:27], s32 offen offset:768 nt
    v_perm_b32 v10, v188, v184, s35
    v_perm_b32 v14, v188, v184, s36
    v_perm_b32 v18, v189, v185, s35
    v_perm_b32 v22, v189, v185, s36
    v_perm_b32 v26, v190, v186, s35
    v_perm_b32 v30, v190, v186, s36
    v_perm_b32 v34, v191, v187, s35
    v_perm_b32 v38, v191, v187, s36
    s_waitcnt vmcnt(19)
    buffer_load_dwordx4 v[184:187], v2, s[24:27], s32 offen offset:1024 nt
    buffer_load_dwordx4 v[188:191], v2, s[24:27], s32 offen offset:1280 nt
    v_perm_b32 v11, v196, v192, s35
    v_perm_b32 v15, v196, v192, s36
    v_perm_b32 v19, v197, v193, s35
    v_mfma_f32_16x16x32_bf16 v[40:43], v[8:11], v[80:83], v[40:43]
    v_perm_b32 v23, v197, v193, s36
    v_perm_b32 v27, v198, v194, s35
    v_mfma_f32_16x16x32_bf16 v[44:47], v[12:15], v[80:83], v[44:47]
    v_perm_b32 v31, v198, v194, s36
    v_perm_b32 v35, v199, v195, s35
    v_mfma_f32_16x16x32_bf16 v[48:51], v[16:19], v[80:83], v[48:51]
    v_perm_b32 v39, v199, v195, s36
    v_mfma_f32_16x16x32_bf16 v[52:55], v[20:23], v[80:83], v[52:55]
    s_waitcnt vmcnt(19)
    buffer_load_dwordx4 v[192:195], v2, s[24:27], s32 offen offset:1536 nt
    buffer_load_dwordx4 v[196:199], v2, s[24:27], s32 offen offset:1792 nt
    v_mfma_f32_16x16x32_bf16 v[56:59], v[24:27], v[80:83], v[56:59]
    v_perm_b32 v8, v204, v200, s35
    v_perm_b32 v12, v204, v200, s36
    v_mfma_f32_16x16x32_bf16 v[60:63], v[28:31], v[80:83], v[60:63]
    v_perm_b32 v16, v205, v201, s35
    v_perm_b32 v20, v205, v201, s36
    v_mfma_f32_16x16x32_bf16 v[64:67], v[32:35], v[80:83], v[64:67]
    v_perm_b32 v24, v206, v202, s35
    v_perm_b32 v28, v206, v202, s36
    v_mfma_f32_16x16x32_bf16 v[68:71], v[36:39], v[80:83], v[68:71]
    v_perm_b32 v32, v207, v203, s35
    v_perm_b32 v36, v207, v203, s36
    s_waitcnt vmcnt(19)
    buffer_load_dwordx4 v[200:203], v2, s[24:27], s32 offen offset:2048 nt
    buffer_load_dwordx4 v[204:207], v2, s[24:27], s32 offen offset:2304 nt
    v_perm_b32 v9, v212, v208, s35
    v_perm_b32 v13, v212, v208, s36
    v_perm_b32 v17, v213, v209, s35
    v_perm_b32 v21, v213, v209, s36
    v_perm_b32 v25, v214, v210, s35
    v_perm_b32 v29, v214, v210, s36
    v_perm_b32 v33, v215, v211, s35
    v_perm_b32 v37, v215, v211, s36
    s_waitcnt vmcnt(19)
    buffer_load_dwordx4 v[208:211], v2, s[24:27], s32 offen offset:2560 nt
    buffer_load_dwordx4 v[212:215], v2, s[24:27], s32 offen offset:2816 nt
    v_perm_b32 v10, v220, v216, s35
    v_perm_b32 v14, v220, v216, s36
    v_perm_b32 v18, v221, v217, s35
    v_perm_b32 v22, v221, v217, s36
    v_perm_b32 v26, v222, v218, s35
    v_perm_b32 v30, v222, v218, s36
    v_perm_b32 v34, v223, v219, s35
    v_perm_b32 v38, v223, v219, s36
    s_waitcnt vmcnt(19)
    buffer_load_dwordx4 v[216:219], v2, s[24:27], s32 offen offset:3072 nt
    buffer_load_dwordx4 v[220:223], v2, s[24:27], s32 offen offset:3328 nt
    v_perm_b32 v11, v228, v224, s35
    v_perm_b32 v15, v228, v224, s36
    v_perm_b32 v19, v229, v225, s35
    v_mfma_f32_16x16x32_bf16 v[40:43], v[8:11], v[84:87], v[40:43]
    v_perm_b32 v23, v229, v225, s36
    v_perm_b32 v27, v230, v226, s35
    v_mfma_f32_16x16x32_bf16 v[44:47], v[12:15], v[84:87], v[44:47]
    v_perm_b32 v31, v230, v226, s36
    v_perm_b32 v35, v231, v227, s35
    v_mfma_f32_16x16x32_bf16 v[48:51], v[16:19], v[84:87], v[48:51]
    v_perm_b32 v39, v231, v227, s36
    v_mfma_f32_16x16x32_bf16 v[52:55], v[20:23], v[84:87], v[52:55]
    s_waitcnt vmcnt(19)
    buffer_load_dwordx4 v[224:227], v2, s[24:27], s32 offen offset:3584 nt
    buffer_load_dwordx4 v[228:231], v2, s[24:27], s32 offen offset:3840 nt
    s_add_u32 s34, s34, 1
    s_and_b32 s34, s34, 31
    s_and_b32 s3, s34, 3
    s_lshl_b32 s3, s3, 14
    s_lshr_b32 s32, s34, 2
    s_lshl_b32 s32, s32, 17
    s_or_b32 s32, s32, s3
    s_lshr_b32 s33, s32, 7
    s_add_u32 s39, s39, 1
    s_cmp_lg_u32 s39, 32
    s_cbranch_scc1 L_adv5
    s_add_u32 s24, s24, 2097152
    s_addc_u32 s25, s25, 0
    s_cmp_eq_u32 s51, 1
    s_cselect_b64 s[24:25], s[28:29], s[24:25]
    s_cselect_b64 s[20:21], s[12:13], s[20:21]
    s_mov_b32 s39, 0
    s_add_u32 s51, s51, 1
    s_cmp_ge_u32 s51, 4
    s_cselect_b32 s26, 0, s26
    s_cselect_b32 s22, 0, s22
L_adv5:
    s_cmp_eq_u32 s86, 0
    s_cbranch_scc1 L_np6
    s_mov_b32 s86, 0
    s_waitcnt lgkmcnt(0)
    s_barrier
L_np6:
    v_mfma_f32_16x16x32_bf16 v[56:59], v[24:27], v[84:87], v[56:59]
    v_perm_b32 v8, v108, v104, s35
    v_perm_b32 v12, v108, v104, s36
    v_mfma_f32_16x16x32_bf16 v[60:63], v[28:31], v[84:87], v[60:63]
    v_perm_b32 v16, v109, v105, s35
    v_perm_b32 v20, v109, v105, s36
    v_mfma_f32_16x16x32_bf16 v[64:67], v[32:35], v[84:87], v[64:67]
    v_perm_b32 v24, v110, v106, s35
    v_perm_b32 v28, v110, v106, s36
    v_mfma_f32_16x16x32_bf16 v[68:71], v[36:39], v[84:87], v[68:71]
    v_perm_b32 v32, v111, v107, s35
    v_perm_b32 v36, v111, v107, s36
    s_waitcnt vmcnt(19)
    buffer_load_dwordx4 v[72:75], v3, s[20:23], s33 offen offset:0
    buffer_load_dwordx4 v[76:79], v3, s[20:23], s33 offen offset:16
    buffer_load_dwordx4 v[80:83], v3, s[20:23], s33 offen offset:32
    buffer_load_dwordx4 v[84:87], v3, s[20:23], s33 offen offset:48
    buffer_load_dwordx4 v[104:107], v1, s[24:27], s32 offen offset:0 nt
    buffer_load_dwordx4 v[108:111], v1, s[24:27], s32 offen offset:256 nt
    v_perm_b32 v9, v116, v112, s35
    v_perm_b32 v13, v116, v112, s36
    v_perm_b32 v17, v117, v113, s35
    v_perm_b32 v21, v117, v113, s36
    v_perm_b32 v25, v118, v114, s35
    v_perm_b32 v29, v118, v114, s36
    v_perm_b32 v33, v119, v115, s35
    v_perm_b32 v37, v119, v115, s36
    s_waitcnt vmcnt(23)
    buffer_load_dwordx4 v[112:115], v1, s[24:27], s32 offen offset:512 nt
    buffer_load_dwordx4 v[116:119], v1, s[24:27], s32 offen offset:768 nt
    v_perm_b32 v10, v124, v120, s35
    v_perm_b32 v14, v124, v120, s36
    v_perm_b32 v18, v125, v121, s35
    v_perm_b32 v22, v125, v121, s36
    v_perm_b32 v26, v126, v122, s35
    v_perm_b32 v30, v126, v122, s36
    v_perm_b32 v34, v127, v123, s35
    v_perm_b32 v38, v127, v123, s36
    s_waitcnt vmcnt(23)
    buffer_load_dwordx4 v[120:123], v1, s[24:27], s32 offen offset:1024 nt
    buffer_load_dwordx4 v[124:127], v1, s[24:27], s32 offen offset:1280 nt
    v_perm_b32 v11, v132, v128, s35
    v_perm_b32 v15, v132, v128, s36
    v_perm_b32 v19, v133, v129, s35
    v_mfma_f32_16x16x32_bf16 v[40:43], v[8:11], v[88:91], v[40:43]
    v_perm_b32 v23, v133, v129, s36
    v_perm_b32 v27, v134, v130, s35
    v_mfma_f32_16x16x32_bf16 v[44:47], v[12:15], v[88:91], v[44:47]
    v_perm_b32 v31, v134, v130, s36
    v_perm_b32 v35, v135, v131, s35
    v_mfma_f32_16x16x32_bf16 v[48:51], v[16:19], v[88:91], v[48:51]
    v_perm_b32 v39, v135, v131, s36
    v_mfma_f32_16x16x32_bf16 v[52:55], v[20:23], v[88:91], v[52:55]
    s_waitcnt vmcnt(23)
    buffer_load_dwordx4 v[128:131], v1, s[24:27], s32 offen offset:1536 nt
    buffer_load_dwordx4 v[132:135], v1, s[24:27], s32 offen offset:1792 nt
    v_mfma_f32_16x16x32_bf16 v[56:59], v[24:27], v[88:91], v[56:59]
    v_perm_b32 v8, v140, v136, s35
    v_perm_b32 v12, v140, v136, s36
    v_mfma_f32_16x16x32_bf16 v[60:63], v[28:31], v[88:91], v[60:63]
    v_perm_b32 v16, v141, v137, s35
    v_perm_b32 v20, v141, v137, s36
    v_mfma_f32_16x16x32_bf16 v[64:67], v[32:35], v[88:91], v[64:67]
    v_perm_b32 v24, v142, v138, s35
    v_perm_b32 v28, v142, v138, s36
    v_mfma_f32_16x16x32_bf16 v[68:71], v[36:39], v[88:91], v[68:71]
    v_perm_b32 v32, v143, v139, s35
    v_perm_b32 v36, v143, v139, s36
    s_waitcnt vmcnt(23)
    buffer_load_dwordx4 v[136:139], v1, s[24:27], s32 offen offset:2048 nt
    buffer_load_dwordx4 v[140:143], v1, s[24:27], s32 offen offset:2304 nt
    v_perm_b32 v9, v148, v144, s35
    v_perm_b32 v13, v148, v144, s36
    v_perm_b32 v17, v149, v145, s35
    v_perm_b32 v21, v149, v145, s36
    v_perm_b32 v25, v150, v146, s35
    v_perm_b32 v29, v150, v146, s36
    v_perm_b32 v33, v151, v147, s35
    v_perm_b32 v37, v151, v147, s36
    s_waitcnt vmcnt(23)
    buffer_load_dwordx4 v[144:147], v1, s[24:27], s32 offen offset:2560 nt
    buffer_load_dwordx4 v[148:151], v1, s[24:27], s32 offen offset:2816 nt
    s_memrealtime s[80:81]
    s_add_u32 s87, s87, 1
    s_add_u32 s82, s82, 1721
    v_readlane_b32 s85, v232, s84
    v_perm_b32 v10, v156, v152, s35
    v_perm_b32 v14, v156, v152, s36
    v_perm_b32 v18, v157, v153, s35
    v_perm_b32 v22, v157, v153, s36
    v_perm_b32 v26, v158, v154, s35
    v_perm_b32 v30, v158, v154, s36
    v_perm_b32 v34, v159, v155, s35
    v_perm_b32 v38, v159, v155, s36
    s_waitcnt vmcnt(23)
    buffer_load_dwordx4 v[152:155], v1, s[24:27], s32 offen offset:3072 nt
    buffer_load_dwordx4 v[156:159], v1, s[24:27], s32 offen offset:3328 nt
    v_perm_b32 v11, v164, v160, s35
    v_perm_b32 v15, v164, v160, s36
    v_perm_b32 v19, v165, v161, s35
    v_mfma_f32_16x16x32_bf16 v[40:43], v[8:11], v[92:95], v[40:43]
    v_perm_b32 v23, v165, v161, s36
    v_perm_b32 v27, v166, v162, s35
    v_mfma_f32_16x16x32_bf16 v[44:47], v[12:15], v[92:95], v[44:47]
    v_perm_b32 v31, v166, v162, s36
    v_perm_b32 v35, v167, v163, s35
    v_mfma_f32_16x16x32_bf16 v[48:51], v[16:19], v[92:95], v[48:51]
    v_perm_b32 v39, v167, v163, s36
    v_mfma_f32_16x16x32_bf16 v[52:55], v[20:23], v[92:95], v[52:55]
    s_waitcnt vmcnt(23)
    buffer_load_dwordx4 v[160:163], v1, s[24:27], s32 offen offset:3584 nt
    buffer_load_dwordx4 v[164:167], v1, s[24:27], s32 offen offset:3840 nt
    v_mfma_f32_16x16x32_bf16 v[56:59], v[24:27], v[92:95], v[56:59]
    v_perm_b32 v8, v172, v168, s35
    v_perm_b32 v12, v172, v168, s36
    v_mfma_f32_16x16x32_bf16 v[60:63], v[28:31], v[92:95], v[60:63]
    v_perm_b32 v16, v173, v169, s35
    v_perm_b32 v20, v173, v169, s36
    v_mfma_f32_16x16x32_bf16 v[64:67], v[32:35], v[92:95], v[64:67]
    v_perm_b32 v24, v174, v170, s35
    v_perm_b32 v28, v174, v170, s36
    v_mfma_f32_16x16x32_bf16 v[68:71], v[36:39], v[92:95], v[68:71]
    v_perm_b32 v32, v175, v171, s35
    v_perm_b32 v36, v175, v171, s36
    s_waitcnt vmcnt(23)
    buffer_load_dwordx4 v[168:171], v2, s[24:27], s32 offen offset:0 nt
    buffer_load_dwordx4 v[172:175], v2, s[24:27], s32 offen offset:256 nt
    s_bfe_u32 s58, s85, 0x180003
    s_lshr_b32 s3, s85, 28
    s_cmp_eq_u32 s3, 8
    s_cselect_b32 s83, s58, s83
    s_cselect_b32 s98, 0, s98
    s_cselect_b32 s77, s76, s77
    s_addc_u32 s84, s84, 0
    s_bitcmp1_b64 s[94:95], s87
    s_cselect_b32 s98, 64, s98
    v_perm_b32 v9, v180, v176, s35
    v_perm_b32 v13, v180, v176, s36
    v_perm_b32 v17, v181, v177, s35
    v_perm_b32 v21, v181, v177, s36
    v_perm_b32 v25, v182, v178, s35
    v_perm_b32 v29, v182, v178, s36
    v_perm_b32 v33, v183, v179, s35
    v_perm_b32 v37, v183, v179, s36
    s_waitcnt vmcnt(23)
    buffer_load_dwordx4 v[176:179], v2, s[24:27], s32 offen offset:512 nt
    buffer_load_dwordx4 v[180:183], v2, s[24:27], s32 offen offset:768 nt
    s_lshr_b32 s3, s82, 3
    s_waitcnt lgkmcnt(0)
    s_sub_u32 s80, s80, s3
    s_sub_u32 s3, s80, s40
    s_mov_b32 s40, s80
    s_cmp_gt_i32 s3, 110
    s_cselect_b32 s3, s3, 0
    s_add_u32 s77, s77, s3
    s_add_u32 s76, s76, s3
    s_bitcmp1_b64 s[100:101], s87
    s_cselect_b32 s76, 0, s76
    s_sub_u32 s89, s80, s77
    s_sub_u32 s89, s89, s83
    s_bfe_i32 s89, s89, 0x180000
    s_bitcmp0_b64 s[90:91], s87
    s_cbranch_scc1 L_rp7
    s_and_b32 s92, s80, 0xffffff
    s_or_b32 s92, s92, 0x10000000
    s_atomic_add s92, s[78:79], s88
    s_add_u32 s88, s88, 4
L_rp7:
    v_perm_b32 v10, v188, v184, s35
    v_perm_b32 v14, v188, v184, s36
    v_perm_b32 v18, v189, v185, s35
    v_perm_b32 v22, v189, v185, s36
    v_perm_b32 v26, v190, v186, s35
    v_perm_b32 v30, v190, v186, s36
    v_perm_b32 v34, v191, v187, s35
    v_perm_b32 v38, v191, v187, s36
    s_waitcnt vmcnt(19)
    buffer_load_dwordx4 v[184:187], v2, s[24:27], s32 offen offset:1024 nt
    buffer_load_dwordx4 v[188:191], v2, s[24:27], s32 offen offset:1280 nt
    v_perm_b32 v11, v196, v192, s35
    v_perm_b32 v15, v196, v192, s36
    v_perm_b32 v19, v197, v193, s35
    v_mfma_f32_16x16x32_bf16 v[40:43], v[8:11], v[96:99], v[40:43]
    v_perm_b32 v23, v197, v193, s36
    v_perm_b32 v27, v198, v194, s35
    v_mfma_f32_16x16x32_bf16 v[44:47], v[12:15], v[96:99], v[44:47]
    v_perm_b32 v31, v198, v194, s36
    v_perm_b32 v35, v199, v195, s35
    v_mfma_f32_16x16x32_bf16 v[48:51], v[16:19], v[96:99], v[48:51]
    v_perm_b32 v39, v199, v195, s36
    v_mfma_f32_16x16x32_bf16 v[52:55], v[20:23], v[96:99], v[52:55]
    s_waitcnt vmcnt(19)
    buffer_load_dwordx4 v[192:195], v2, s[24:27], s32 offen offset:1536 nt
    buffer_load_dwordx4 v[196:199], v2, s[24:27], s32 offen offset:1792 nt
    v_mfma_f32_16x16x32_bf16 v[56:59], v[24:27], v[96:99], v[56:59]
    v_perm_b32 v8, v204, v200, s35
    v_perm_b32 v12, v204, v200, s36
    v_mfma_f32_16x16x32_bf16 v[60:63], v[28:31], v[96:99], v[60:63]
    v_perm_b32 v16, v205, v201, s35
    v_perm_b32 v20, v205, v201, s36
    v_mfma_f32_16x16x32_bf16 v[64:67], v[32:35], v[96:99], v[64:67]
    v_perm_b32 v24, v206, v202, s35
    v_perm_b32 v28, v206, v202, s36
    v_mfma_f32_16x16x32_bf16 v[68:71], v[36:39], v[96:99], v[68:71]
    v_perm_b32 v32, v207, v203, s35
    v_perm_b32 v36, v207, v203, s36
    s_waitcnt vmcnt(19)
    buffer_load_dwordx4 v[200:203], v2, s[24:27], s32 offen offset:2048 nt
    buffer_load_dwordx4 v[204:207], v2, s[24:27], s32 offen offset:2304 nt
    s_mov_b32 s93, 0
    s_cmp_ge_u32 s87, 52
    s_cselect_b32 s3, 1, 0
    s_lshl_b32 s89, s89, s3
    s_cmp_ge_i32 s89, -80
    s_addc_u32 s93, s93, 0
    s_cmp_ge_i32 s89, 80
    s_addc_u32 s93, s93, 0
    s_cmp_ge_i32 s89, 250
    s_addc_u32 s93, s93, 0
    s_cmp_eq_u32 s83, -1
    s_cselect_b32 s93, 1, s93
    s_cmp_lt_i32 s89, 80
    s_cselect_b32 s3, 5, 4
    s_cmp_ge_u32 s87, 63
    s_cselect_b32 s93, s3, s93
    v_perm_b32 v9, v212, v208, s35
    v_perm_b32 v13, v212, v208, s36
    v_perm_b32 v17, v213, v209, s35
    v_perm_b32 v21, v213, v209, s36
    v_perm_b32 v25, v214, v210, s35
    v_perm_b32 v29, v214, v210, s36
    v_perm_b32 v33, v215, v211, s35
    v_perm_b32 v37, v215, v211, s36
    s_waitcnt vmcnt(19)
    buffer_load_dwordx4 v[208:211], v2, s[24:27], s32 offen offset:2560 nt
    buffer_load_dwordx4 v[212:215], v2, s[24:27], s32 offen offset:2816 nt
    v_perm_b32 v10, v220, v216, s35
    v_perm_b32 v14, v220, v216, s36
    v_perm_b32 v18, v221, v217, s35
    v_perm_b32 v22, v221, v217, s36
    v_perm_b32 v26, v222, v218, s35
    v_perm_b32 v30, v222, v218, s36
    v_perm_b32 v34, v223, v219, s35
    v_perm_b32 v38, v223, v219, s36
    s_waitcnt vmcnt(19)
    buffer_load_dwordx4 v[216:219], v2, s[24:27], s32 offen offset:3072 nt
    buffer_load_dwordx4 v[220:223], v2, s[24:27], s32 offen offset:3328 nt
    v_perm_b32 v11, v228, v224, s35
    v_perm_b32 v15, v228, v224, s36
    v_perm_b32 v19, v229, v225, s35
    v_mfma_f32_16x16x32_bf16 v[40:43], v[8:11], v[100:103], v[40:43]
    v_perm_b32 v23, v229, v225, s36
    v_perm_b32 v27, v230, v226, s35
    v_mfma_f32_16x16x32_bf16 v[44:47], v[12:15], v[100:103], v[44:47]
    v_perm_b32 v31, v230, v226, s36
    v_perm_b32 v35, v231, v227, s35
    v_mfma_f32_16x16x32_bf16 v[48:51], v[16:19], v[100:103], v[48:51]
    v_perm_b32 v39, v231, v227, s36
    v_mfma_f32_16x16x32_bf16 v[52:55], v[20:23], v[100:103], v[52:55]
    s_waitcnt vmcnt(19)
    buffer_load_dwordx4 v[224:227], v2, s[24:27], s32 offen offset:3584 nt
    buffer_load_dwordx4 v[228:231], v2, s[24:27], s32 offen offset:3840 nt
    v_mfma_f32_16x16x32_bf16 v[56:59], v[24:27], v[100:103], v[56:59]
    v_mfma_f32_16x16x32_bf16 v[60:63], v[28:31], v[100:103], v[60:63]
    v_mfma_f32_16x16x32_bf16 v[64:67], v[32:35], v[100:103], v[64:67]
    v_mfma_f32_16x16x32_bf16 v[68:71], v[36:39], v[100:103], v[68:71]
    s_sub_u32 s38, s38, 1
    s_cbranch_scc1 L_k_done
    s_cmp_eq_u32 s93, 1
    s_cbranch_scc1 L_k1
    s_branch L_k_top
    .p2align 3
L_k0:
    s_add_u32 s34, s34, 1
    s_and_b32 s34, s34, 31
    s_and_b32 s3, s34, 3
    s_lshl_b32 s3, s3, 14
    s_lshr_b32 s32, s34, 2
    s_lshl_b32 s32, s32, 17
    s_or_b32 s32, s32, s3
    s_lshr_b32 s33, s32, 7
    s_add_u32 s39, s39, 1
    s_cmp_lg_u32 s39, 32
    s_cbranch_scc1 L_adv8
    s_add_u32 s24, s24, 2097152
    s_addc_u32 s25, s25, 0
    s_cmp_eq_u32 s51, 1
    s_cselect_b64 s[24:25], s[28:29], s[24:25]
    s_cselect_b64 s[20:21], s[12:13], s[20:21]
    s_mov_b32 s39, 0
    s_add_u32 s51, s51, 1
    s_cmp_ge_u32 s51, 4
    s_cselect_b32 s26, 0, s26
    s_cselect_b32 s22, 0, s22
L_adv8:
    s_waitcnt vmcnt(30)
    v_perm_b32 v8, v108, v104, s35
    v_perm_b32 v12, v108, v104, s36
    v_perm_b32 v16, v109, v105, s35
    v_perm_b32 v20, v109, v105, s36
    v_perm_b32 v24, v110, v106, s35
    v_perm_b32 v28, v110, v106, s36
    v_perm_b32 v32, v111, v107, s35
    v_perm_b32 v36, v111, v107, s36
    s_waitcnt vmcnt(17)
    buffer_load_dwordx4 v[88:91], v3, s[20:23], s33 offen offset:0
    buffer_load_dwordx4 v[92:95], v3, s[20:23], s33 offen offset:16
    buffer_load_dwordx4 v[96:99], v3, s[20:23], s33 offen offset:32
    buffer_load_dwordx4 v[100:103], v3, s[20:23], s33 offen offset:48
    buffer_load_dword v232, v233, s[96:99], 0 offen sc1
    buffer_load_dwordx4 v[104:107], v1, s[24:27], s32 offen offset:0 nt
    buffer_load_dwordx4 v[108:111], v1, s[24:27], s32 offen offset:256 nt
    s_cmp_lg_u32 s86, 1
    s_cbranch_scc1 L_nd9
    ds_write_b128 v4, v[40:43] offset:0
    ds_write_b128 v4, v[44:47] offset:1024
    ds_write_b128 v4, v[48:51] offset:2048
    ds_write_b128 v4, v[52:55] offset:3072
L_nd9:
    v_perm_b32 v9, v116, v112, s35
    v_perm_b32 v13, v116, v112, s36
    v_perm_b32 v17, v117, v113, s35
    v_perm_b32 v21, v117, v113, s36
    v_perm_b32 v25, v118, v114, s35
    v_perm_b32 v29, v118, v114, s36
    v_perm_b32 v33, v119, v115, s35
    v_perm_b32 v37, v119, v115, s36
    s_waitcnt vmcnt(22)
    buffer_load_dwordx4 v[112:115], v1, s[24:27], s32 offen offset:512 nt
    buffer_load_dwordx4 v[116:119], v1, s[24:27], s32 offen offset:768 nt
    s_cmp_lg_u32 s86, 1
    s_cbranch_scc1 L_nd10
    ds_write_b128 v4, v[56:59] offset:4096
    ds_write_b128 v4, v[60:63] offset:5120
    ds_write_b128 v4, v[64:67] offset:6144
    ds_write_b128 v4, v[68:71] offset:7168
    v_mov_b64 v[40:41], 0
    v_mov_b64 v[42:43], 0
    v_mov_b64 v[44:45], 0
    v_mov_b64 v[46:47], 0
    v_mov_b64 v[48:49], 0
    v_mov_b64 v[50:51], 0
    v_mov_b64 v[52:53], 0
    v_mov_b64 v[54:55], 0
L_nd10:
    v_perm_b32 v10, v124, v120, s35
    v_perm_b32 v14, v124, v120, s36
    v_perm_b32 v18, v125, v121, s35
    v_perm_b32 v22, v125, v121, s36
    v_perm_b32 v26, v126, v122, s35
    v_perm_b32 v30, v126, v122, s36
    v_perm_b32 v34, v127, v123, s35
    v_perm_b32 v38, v127, v123, s36
    s_waitcnt vmcnt(22)
    buffer_load_dwordx4 v[120:123], v1, s[24:27], s32 offen offset:1024 nt
    buffer_load_dwordx4 v[124:127], v1, s[24:27], s32 offen offset:1280 nt
    s_cmp_lg_u32 s86, 1
    s_cbranch_scc1 L_nd11
    v_mov_b64 v[56:57], 0
    v_mov_b64 v[58:59], 0
    v_mov_b64 v[60:61], 0
    v_mov_b64 v[62:63], 0
    v_mov_b64 v[64:65], 0
    v_mov_b64 v[66:67], 0
    v_mov_b64 v[68:69], 0
    v_mov_b64 v[70:71], 0
L_nd11:
    v_perm_b32 v11, v132, v128, s35
    v_perm_b32 v15, v132, v128, s36
    v_perm_b32 v19, v133, v129, s35
    v_mfma_f32_16x16x32_bf16 v[40:43], v[8:11], v[72:75], v[40:43]
    v_perm_b32 v23, v133, v129, s36
    v_perm_b32 v27, v134, v130, s35
    v_mfma_f32_16x16x32_bf16 v[44:47], v[12:15], v[72:75], v[44:47]
    v_perm_b32 v31, v134, v130, s36
    v_perm_b32 v35, v135, v131, s35
    v_mfma_f32_16x16x32_bf16 v[48:51], v[16:19], v[72:75], v[48:51]
    v_perm_b32 v39, v135, v131, s36
    v_mfma_f32_16x16x32_bf16 v[52:55], v[20:23], v[72:75], v[52:55]
    s_waitcnt vmcnt(22)
    buffer_load_dwordx4 v[128:131], v1, s[24:27], s32 offen offset:1536 nt
    buffer_load_dwordx4 v[132:135], v1, s[24:27], s32 offen offset:1792 nt
    v_mfma_f32_16x16x32_bf16 v[56:59], v[24:27], v[72:75], v[56:59]
    v_perm_b32 v8, v140, v136, s35
    v_perm_b32 v12, v140, v136, s36
    v_mfma_f32_16x16x32_bf16 v[60:63], v[28:31], v[72:75], v[60:63]
    v_perm_b32 v16, v141, v137, s35
    v_perm_b32 v20, v141, v137, s36
    v_mfma_f32_16x16x32_bf16 v[64:67], v[32:35], v[72:75], v[64:67]
    v_perm_b32 v24, v142, v138, s35
    v_perm_b32 v28, v142, v138, s36
    v_mfma_f32_16x16x32_bf16 v[68:71], v[36:39], v[72:75], v[68:71]
    v_perm_b32 v32, v143, v139, s35
    v_perm_b32 v36, v143, v139, s36
    s_waitcnt vmcnt(22)
    buffer_load_dwordx4 v[136:139], v1, s[24:27], s32 offen offset:2048 nt
    buffer_load_dwordx4 v[140:143], v1, s[24:27], s32 offen offset:2304 nt
    v_perm_b32 v9, v148, v144, s35
    v_perm_b32 v13, v148, v144, s36
    v_perm_b32 v17, v149, v145, s35
    v_perm_b32 v21, v149, v145, s36
    v_perm_b32 v25, v150, v146, s35
    v_perm_b32 v29, v150, v146, s36
    v_perm_b32 v33, v151, v147, s35
    v_perm_b32 v37, v151, v147, s36
    s_waitcnt vmcnt(22)
    buffer_load_dwordx4 v[144:147], v1, s[24:27], s32 offen offset:2560 nt
    buffer_load_dwordx4 v[148:151], v1, s[24:27], s32 offen offset:2816 nt
    v_perm_b32 v10, v156, v152, s35
    v_perm_b32 v14, v156, v152, s36
    v_perm_b32 v18, v157, v153, s35
    v_perm_b32 v22, v157, v153, s36
    v_perm_b32 v26, v158, v154, s35
    v_perm_b32 v30, v158, v154, s36
    v_perm_b32 v34, v159, v155, s35
    v_perm_b32 v38, v159, v155, s36
    s_waitcnt vmcnt(22)
    buffer_load_dwordx4 v[152:155], v1, s[24:27], s32 offen offset:3072 nt
    buffer_load_dwordx4 v[156:159], v1, s[24:27], s32 offen offset:3328 nt
    v_perm_b32 v11, v164, v160, s35
    v_perm_b32 v15, v164, v160, s36
    v_perm_b32 v19, v165, v161, s35
    v_mfma_f32_16x16x32_bf16 v[40:43], v[8:11], v[76:79], v[40:43]
    v_perm_b32 v23, v165, v161, s36
    v_perm_b32 v27, v166, v162, s35
    v_mfma_f32_16x16x32_bf16 v[44:47], v[12:15], v[76:79], v[44:47]
    v_perm_b32 v31, v166, v162, s36
    v_perm_b32 v35, v167, v163, s35
    v_mfma_f32_16x16x32_bf16 v[48:51], v[16:19], v[76:79], v[48:51]
    v_perm_b32 v39, v167, v163, s36
    v_mfma_f32_16x16x32_bf16 v[52:55], v[20:23], v[76:79], v[52:55]
    s_waitcnt vmcnt(22)
    buffer_load_dwordx4 v[160:163], v1, s[24:27], s32 offen offset:3584 nt
    buffer_load_dwordx4 v[164:167], v1, s[24:27], s32 offen offset:3840 nt
    v_mfma_f32_16x16x32_bf16 v[56:59], v[24:27], v[76:79], v[56:59]
    v_perm_b32 v8, v172, v168, s35
    v_perm_b32 v12, v172, v168, s36
    v_mfma_f32_16x16x32_bf16 v[60:63], v[28:31], v[76:79], v[60:63]
    v_perm_b32 v16, v173, v169, s35
    v_perm_b32 v20, v173, v169, s36
    v_mfma_f32_16x16x32_bf16 v[64:67], v[32:35], v[76:79], v[64:67]
    v_perm_b32 v24, v174, v170, s35
    v_perm_b32 v28, v174, v170, s36
    v_mfma_f32_16x16x32_bf16 v[68:71], v[36:39], v[76:79], v[68:71]
    v_perm_b32 v32, v175, v171, s35
    v_perm_b32 v36, v175, v171, s36
    s_waitcnt vmcnt(22)
    buffer_load_dwordx4 v[168:171], v2, s[24:27], s32 offen offset:0 nt
    buffer_load_dwordx4 v[172:175], v2, s[24:27], s32 offen offset:256 nt
    v_perm_b32 v9, v180, v176, s35
    v_perm_b32 v13, v180, v176, s36
    v_perm_b32 v17, v181, v177, s35
    v_perm_b32 v21, v181, v177, s36
    v_perm_b32 v25, v182, v178, s35
    v_perm_b32 v29, v182, v178, s36
    v_perm_b32 v33, v183, v179, s35
    v_perm_b32 v37, v183, v179, s36
    s_waitcnt vmcnt(17)
    buffer_load_dwordx4 v[176:179], v2, s[24:27], s32 offen offset:512 nt
    buffer_load_dwordx4 v[180:183], v2, s[24:27], s32 offen offset:768 nt
    v_perm_b32 v10, v188, v184, s35
    v_perm_b32 v14, v188, v184, s36
    v_perm_b32 v18, v189, v185, s35
    v_perm_b32 v22, v189, v185, s36
    v_perm_b32 v26, v190, v186, s35
    v_perm_b32 v30, v190, v186, s36
    v_perm_b32 v34, v191, v187, s35
    v_perm_b32 v38, v191, v187, s36
    s_waitcnt vmcnt(17)
    buffer_load_dwordx4 v[184:187], v2, s[24:27], s32 offen offset:1024 nt
    buffer_load_dwordx4 v[188:191], v2, s[24:27], s32 offen offset:1280 nt
    v_perm_b32 v11, v196, v192, s35
    v_perm_b32 v15, v196, v192, s36
    v_perm_b32 v19, v197, v193, s35
    v_mfma_f32_16x16x32_bf16 v[40:43], v[8:11], v[80:83], v[40:43]
    v_perm_b32 v23, v197, v193, s36
    v_perm_b32 v27, v198, v194, s35
    v_mfma_f32_16x16x32_bf16 v[44:47], v[12:15], v[80:83], v[44:47]
    v_perm_b32 v31, v198, v194, s36
    v_perm_b32 v35, v199, v195, s35
    v_mfma_f32_16x16x32_bf16 v[48:51], v[16:19], v[80:83], v[48:51]
    v_perm_b32 v39, v199, v195, s36
    v_mfma_f32_16x16x32_bf16 v[52:55], v[20:23], v[80:83], v[52:55]
    s_waitcnt vmcnt(17)
    buffer_load_dwordx4 v[192:195], v2, s[24:27], s32 offen offset:1536 nt
    buffer_load_dwordx4 v[196:199], v2, s[24:27], s32 offen offset:1792 nt
    v_mfma_f32_16x16x32_bf16 v[56:59], v[24:27], v[80:83], v[56:59]
    v_perm_b32 v8, v204, v200, s35
    v_perm_b32 v12, v204, v200, s36
    v_mfma_f32_16x16x32_bf16 v[60:63], v[28:31], v[80:83], v[60:63]
    v_perm_b32 v16, v205, v201, s35
    v_perm_b32 v20, v205, v201, s36
    v_mfma_f32_16x16x32_bf16 v[64:67], v[32:35], v[80:83], v[64:67]
    v_perm_b32 v24, v206, v202, s35
    v_perm_b32 v28, v206, v202, s36
    v_mfma_f32_16x16x32_bf16 v[68:71], v[36:39], v[80:83], v[68:71]
    v_perm_b32 v32, v207, v203, s35
    v_perm_b32 v36, v207, v203, s36
    s_waitcnt vmcnt(17)
    buffer_load_dwordx4 v[200:203], v2, s[24:27], s32 offen offset:2048 nt
    buffer_load_dwordx4 v[204:207], v2, s[24:27], s32 offen offset:2304 nt
    v_perm_b32 v9, v212, v208, s35
    v_perm_b32 v13, v212, v208, s36
    v_perm_b32 v17, v213, v209, s35
    v_perm_b32 v21, v213, v209, s36
    v_perm_b32 v25, v214, v210, s35
    v_perm_b32 v29, v214, v210, s36
    v_perm_b32 v33, v215, v211, s35
    v_perm_b32 v37, v215, v211, s36
    s_waitcnt vmcnt(17)
    buffer_load_dwordx4 v[208:211], v2, s[24:27], s32 offen offset:2560 nt
    buffer_load_dwordx4 v[212:215], v2, s[24:27], s32 offen offset:2816 nt
    v_perm_b32 v10, v220, v216, s35
    v_perm_b32 v14, v220, v216, s36
    v_perm_b32 v18, v221, v217, s35
    v_perm_b32 v22, v221, v217, s36
    v_perm_b32 v26, v222, v218, s35
    v_perm_b32 v30, v222, v218, s36
    v_perm_b32 v34, v223, v219, s35
    v_perm_b32 v38, v223, v219, s36
    s_waitcnt vmcnt(17)
    buffer_load_dwordx4 v[216:219], v2, s[24:27], s32 offen offset:3072 nt
    buffer_load_dwordx4 v[220:223], v2, s[24:27], s32 offen offset:3328 nt
    v_perm_b32 v11, v228, v224, s35
    v_perm_b32 v15, v228, v224, s36
    v_perm_b32 v19, v229, v225, s35
    v_mfma_f32_16x16x32_bf16 v[40:43], v[8:11], v[84:87], v[40:43]
    v_perm_b32 v23, v229, v225, s36
    v_perm_b32 v27, v230, v226, s35
    v_mfma_f32_16x16x32_bf16 v[44:47], v[12:15], v[84:87], v[44:47]
    v_perm_b32 v31, v230, v226, s36
    v_perm_b32 v35, v231, v227, s35
    v_mfma_f32_16x16x32_bf16 v[48:51], v[16:19], v[84:87], v[48:51]
    v_perm_b32 v39, v231, v227, s36
    v_mfma_f32_16x16x32_bf16 v[52:55], v[20:23], v[84:87], v[52:55]
    s_waitcnt vmcnt(17)
    buffer_load_dwordx4 v[224:227], v2, s[24:27], s32 offen offset:3584 nt
    buffer_load_dwordx4 v[228:231], v2, s[24:27], s32 offen offset:3840 nt
    s_add_u32 s34, s34, 1
    s_and_b32 s34, s34, 31
    s_and_b32 s3, s34, 3
    s_lshl_b32 s3, s3, 14
    s_lshr_b32 s32, s34, 2
    s_lshl_b32 s32, s32, 17
    s_or_b32 s32, s32, s3
    s_lshr_b32 s33, s32, 7
    s_add_u32 s39, s39, 1
    s_cmp_lg_u32 s39, 32
    s_cbranch_scc1 L_adv12
    s_add_u32 s24, s24, 2097152
    s_addc_u32 s25, s25, 0
    s_cmp_eq_u32 s51, 1
    s_cselect_b64 s[24:25], s[28:29], s[24:25]
    s_cselect_b64 s[20:21], s[12:13], s[20:21]
    s_mov_b32 s39, 0
    s_add_u32 s51, s51, 1
    s_cmp_ge_u32 s51, 4
    s_cselect_b32 s26, 0, s26
    s_cselect_b32 s22, 0, s22
L_adv12:
    s_cmp_eq_u32 s86, 0
    s_cbranch_scc1 L_np13
    s_mov_b32 s86, 0
    s_waitcnt lgkmcnt(0)
    s_barrier
L_np13:
    v_mfma_f32_16x16x32_bf16 v[56:59], v[24:27], v[84:87], v[56:59]
    v_perm_b32 v8, v108, v104, s35
    v_perm_b32 v12, v108, v104, s36
    v_mfma_f32_16x16x32_bf16 v[60:63], v[28:31], v[84:87], v[60:63]
    v_perm_b32 v16, v109, v105, s35
    v_perm_b32 v20, v109, v105, s36
    v_mfma_f32_16x16x32_bf16 v[64:67], v[32:35], v[84:87], v[64:67]
    v_perm_b32 v24, v110, v106, s35
    v_perm_b32 v28, v110, v106, s36
    v_mfma_f32_16x16x32_bf16 v[68:71], v[36:39], v[84:87], v[68:71]
    v_perm_b32 v32, v111, v107, s35
    v_perm_b32 v36, v111, v107, s36
    s_waitcnt vmcnt(17)
    buffer_load_dwordx4 v[72:75], v3, s[20:23], s33 offen offset:0
    buffer_load_dwordx4 v[76:79], v3, s[20:23], s33 offen offset:16
    buffer_load_dwordx4 v[80:83], v3, s[20:23], s33 offen offset:32
    buffer_load_dwordx4 v[84:87], v3, s[20:23], s33 offen offset:48
    buffer_load_dwordx4 v[104:107], v1, s[24:27], s32 offen offset:0 nt
    buffer_load_dwordx4 v[108:111], v1, s[24:27], s32 offen offset:256 nt
    v_perm_b32 v9, v116, v112, s35
    v_perm_b32 v13, v116, v112, s36
    v_perm_b32 v17, v117, v113, s35
    v_perm_b32 v21, v117, v113, s36
    v_perm_b32 v25, v118, v114, s35
    v_perm_b32 v29, v118, v114, s36
    v_perm_b32 v33, v119, v115, s35
    v_perm_b32 v37, v119, v115, s36
    s_waitcnt vmcnt(21)
    buffer_load_dwordx4 v[112:115], v1, s[24:27], s32 offen offset:512 nt
    buffer_load_dwordx4 v[116:119], v1, s[24:27], s32 offen offset:768 nt
    v_perm_b32 v10, v124, v120, s35
    v_perm_b32 v14, v124, v120, s36
    v_perm_b32 v18, v125, v121, s35
    v_perm_b32 v22, v125, v121, s36
    v_perm_b32 v26, v126, v122, s35
    v_perm_b32 v30, v126, v122, s36
    v_perm_b32 v34, v127, v123, s35
    v_perm_b32 v38, v127, v123, s36
    s_waitcnt vmcnt(21)
    buffer_load_dwordx4 v[120:123], v1, s[24:27], s32 offen offset:1024 nt
    buffer_load_dwordx4 v[124:127], v1, s[24:27], s32 offen offset:1280 nt
    v_perm_b32 v11, v132, v128, s35
    v_perm_b32 v15, v132, v128, s36
    v_perm_b32 v19, v133, v129, s35
    v_mfma_f32_16x16x32_bf16 v[40:43], v[8:11], v[88:91], v[40:43]
    v_perm_b32 v23, v133, v129, s36
    v_perm_b32 v27, v134, v130, s35
    v_mfma_f32_16x16x32_bf16 v[44:47], v[12:15], v[88:91], v[44:47]
    v_perm_b32 v31, v134, v130, s36
    v_perm_b32 v35, v135, v131, s35
    v_mfma_f32_16x16x32_bf16 v[48:51], v[16:19], v[88:91], v[48:51]
    v_perm_b32 v39, v135, v131, s36
    v_mfma_f32_16x16x32_bf16 v[52:55], v[20:23], v[88:91], v[52:55]
    s_waitcnt vmcnt(21)
    buffer_load_dwordx4 v[128:131], v1, s[24:27], s32 offen offset:1536 nt
    buffer_load_dwordx4 v[132:135], v1, s[24:27], s32 offen offset:1792 nt
    v_mfma_f32_16x16x32_bf16 v[56:59], v[24:27], v[88:91], v[56:59]
    v_perm_b32 v8, v140, v136, s35
    v_perm_b32 v12, v140, v136, s36
    v_mfma_f32_16x16x32_bf16 v[60:63], v[28:31], v[88:91], v[60:63]
    v_perm_b32 v16, v141, v137, s35
    v_perm_b32 v20, v141, v137, s36
    v_mfma_f32_16x16x32_bf16 v[64:67], v[32:35], v[88:91], v[64:67]
    v_perm_b32 v24, v142, v138, s35
    v_perm_b32 v28, v142, v138, s36
    v_mfma_f32_16x16x32_bf16 v[68:71], v[36:39], v[88:91], v[68:71]
    v_perm_b32 v32, v143, v139, s35
    v_perm_b32 v36, v143, v139, s36
    s_waitcnt vmcnt(21)
    buffer_load_dwordx4 v[136:139], v1, s[24:27], s32 offen offset:2048 nt
    buffer_load_dwordx4 v[140:143], v1, s[24:27], s32 offen offset:2304 nt
    v_perm_b32 v9, v148, v144, s35
    v_perm_b32 v13, v148, v144, s36
    v_perm_b32 v17, v149, v145, s35
    v_perm_b32 v21, v149, v145, s36
    v_perm_b32 v25, v150, v146, s35
    v_perm_b32 v29, v150, v146, s36
    v_perm_b32 v33, v151, v147, s35
    v_perm_b32 v37, v151, v147, s36
    s_waitcnt vmcnt(21)
    buffer_load_dwordx4 v[144:147], v1, s[24:27], s32 offen offset:2560 nt
    buffer_load_dwordx4 v[148:151], v1, s[24:27], s32 offen offset:2816 nt
    s_memrealtime s[80:81]
    s_add_u32 s87, s87, 1
    s_add_u32 s82, s82, 1721
    v_readlane_b32 s85, v232, s84
    v_perm_b32 v10, v156, v152, s35
    v_perm_b32 v14, v156, v152, s36
    v_perm_b32 v18, v157, v153, s35
    v_perm_b32 v22, v157, v153, s36
    v_perm_b32 v26, v158, v154, s35
    v_perm_b32 v30, v158, v154, s36
    v_perm_b32 v34, v159, v155, s35
    v_perm_b32 v38, v159, v155, s36
    s_waitcnt vmcnt(21)
    buffer_load_dwordx4 v[152:155], v1, s[24:27], s32 offen offset:3072 nt
    buffer_load_dwordx4 v[156:159], v1, s[24:27], s32 offen offset:3328 nt
    v_perm_b32 v11, v164, v160, s35
    v_perm_b32 v15, v164, v160, s36
    v_perm_b32 v19, v165, v161, s35
    v_mfma_f32_16x16x32_bf16 v[40:43], v[8:11], v[92:95], v[40:43]
    v_perm_b32 v23, v165, v161, s36
    v_perm_b32 v27, v166, v162, s35
    v_mfma_f32_16x16x32_bf16 v[44:47], v[12:15], v[92:95], v[44:47]
    v_perm_b32 v31, v166, v162, s36
    v_perm_b32 v35, v167, v163, s35
    v_mfma_f32_16x16x32_bf16 v[48:51], v[16:19], v[92:95], v[48:51]
    v_perm_b32 v39, v167, v163, s36
    v_mfma_f32_16x16x32_bf16 v[52:55], v[20:23], v[92:95], v[52:55]
    s_waitcnt vmcnt(21)
    buffer_load_dwordx4 v[160:163], v1, s[24:27], s32 offen offset:3584 nt
    buffer_load_dwordx4 v[164:167], v1, s[24:27], s32 offen offset:3840 nt
    v_mfma_f32_16x16x32_bf16 v[56:59], v[24:27], v[92:95], v[56:59]
    v_perm_b32 v8, v172, v168, s35
    v_perm_b32 v12, v172, v168, s36
    v_mfma_f32_16x16x32_bf16 v[60:63], v[28:31], v[92:95], v[60:63]
    v_perm_b32 v16, v173, v169, s35
    v_perm_b32 v20, v173, v169, s36
    v_mfma_f32_16x16x32_bf16 v[64:67], v[32:35], v[92:95], v[64:67]
    v_perm_b32 v24, v174, v170, s35
    v_perm_b32 v28, v174, v170, s36
    v_mfma_f32_16x16x32_bf16 v[68:71], v[36:39], v[92:95], v[68:71]
    v_perm_b32 v32, v175, v171, s35
    v_perm_b32 v36, v175, v171, s36
    s_waitcnt vmcnt(21)
    buffer_load_dwordx4 v[168:171], v2, s[24:27], s32 offen offset:0 nt
    buffer_load_dwordx4 v[172:175], v2, s[24:27], s32 offen offset:256 nt
    s_bfe_u32 s58, s85, 0x180003
    s_lshr_b32 s3, s85, 28
    s_cmp_eq_u32 s3, 8
    s_cselect_b32 s83, s58, s83
    s_cselect_b32 s98, 0, s98
    s_cselect_b32 s77, s76, s77
    s_addc_u32 s84, s84, 0
    s_bitcmp1_b64 s[94:95], s87
    s_cselect_b32 s98, 64, s98
    v_perm_b32 v9, v180, v176, s35
    v_perm_b32 v13, v180, v176, s36
    v_perm_b32 v17, v181, v177, s35
    v_perm_b32 v21, v181, v177, s36
    v_perm_b32 v25, v182, v178, s35
    v_perm_b32 v29, v182, v178, s36
    v_perm_b32 v33, v183, v179, s35
    v_perm_b32 v37, v183, v179, s36
    s_waitcnt vmcnt(17)
    buffer_load_dwordx4 v[176:179], v2, s[24:27], s32 offen offset:512 nt
    buffer_load_dwordx4 v[180:183], v2, s[24:27], s32 offen offset:768 nt
    s_lshr_b32 s3, s82, 3
    s_waitcnt lgkmcnt(0)
    s_sub_u32 s80, s80, s3
    s_sub_u32 s3, s80, s40
    s_mov_b32 s40, s80
    s_cmp_gt_i32 s3, 110
    s_cselect_b32 s3, s3, 0
    s_add_u32 s77, s77, s3
    s_add_u32 s76, s76, s3
    s_bitcmp1_b64 s[100:101], s87
    s_cselect_b32 s76, 0, s76
    s_sub_u32 s89, s80, s77
    s_sub_u32 s89, s89, s83
    s_bfe_i32 s89, s89, 0x180000
    s_bitcmp0_b64 s[90:91], s87
    s_cbranch_scc1 L_rp14
    s_and_b32 s92, s80, 0xffffff
    s_or_b32 s92, s92, 0x10000000
    s_atomic_add s92, s[78:79], s88
    s_add_u32 s88, s88, 4
L_rp14:
    v_perm_b32 v10, v188, v184, s35
    v_perm_b32 v14, v188, v184, s36
    v_perm_b32 v18, v189, v185, s35
    v_perm_b32 v22, v189, v185, s36
    v_perm_b32 v26, v190, v186, s35
    v_perm_b32 v30, v190, v186, s36
    v_perm_b32 v34, v191, v187, s35
    v_perm_b32 v38, v191, v187, s36
    s_waitcnt vmcnt(17)
    buffer_load_dwordx4 v[184:187], v2, s[24:27], s32 offen offset:1024 nt
    buffer_load_dwordx4 v[188:191], v2, s[24:27], s32 offen offset:1280 nt
    v_perm_b32 v11, v196, v192, s35
    v_perm_b32 v15, v196, v192, s36
    v_perm_b32 v19, v197, v193, s35
    v_mfma_f32_16x16x32_bf16 v[40:43], v[8:11], v[96:99], v[40:43]
    v_perm_b32 v23, v197, v193, s36
    v_perm_b32 v27, v198, v194, s35
    v_mfma_f32_16x16x32_bf16 v[44:47], v[12:15], v[96:99], v[44:47]
    v_perm_b32 v31, v198, v194, s36
    v_perm_b32 v35, v199, v195, s35
    v_mfma_f32_16x16x32_bf16 v[48:51], v[16:19], v[96:99], v[48:51]
    v_perm_b32 v39, v199, v195, s36
    v_mfma_f32_16x16x32_bf16 v[52:55], v[20:23], v[96:99], v[52:55]
    s_waitcnt vmcnt(17)
    buffer_load_dwordx4 v[192:195], v2, s[24:27], s32 offen offset:1536 nt
    buffer_load_dwordx4 v[196:199], v2, s[24:27], s32 offen offset:1792 nt
    v_mfma_f32_16x16x32_bf16 v[56:59], v[24:27], v[96:99], v[56:59]
    v_perm_b32 v8, v204, v200, s35
    v_perm_b32 v12, v204, v200, s36
    v_mfma_f32_16x16x32_bf16 v[60:63], v[28:31], v[96:99], v[60:63]
    v_perm_b32 v16, v205, v201, s35
    v_perm_b32 v20, v205, v201, s36
    v_mfma_f32_16x16x32_bf16 v[64:67], v[32:35], v[96:99], v[64:67]
    v_perm_b32 v24, v206, v202, s35
    v_perm_b32 v28, v206, v202, s36
    v_mfma_f32_16x16x32_bf16 v[68:71], v[36:39], v[96:99], v[68:71]
    v_perm_b32 v32, v207, v203, s35
    v_perm_b32 v36, v207, v203, s36
    s_waitcnt vmcnt(17)
    buffer_load_dwordx4 v[200:203], v2, s[24:27], s32 offen offset:2048 nt
    buffer_load_dwordx4 v[204:207], v2, s[24:27], s32 offen offset:2304 nt
    s_mov_b32 s93, 0
    s_cmp_ge_u32 s87, 52
    s_cselect_b32 s3, 1, 0
    s_lshl_b32 s89, s89, s3
    s_cmp_ge_i32 s89, -80
    s_addc_u32 s93, s93, 0
    s_cmp_ge_i32 s89, 80
    s_addc_u32 s93, s93, 0
    s_cmp_ge_i32 s89, 250
    s_addc_u32 s93, s93, 0
    s_cmp_eq_u32 s83, -1
    s_cselect_b32 s93, 1, s93
    s_cmp_lt_i32 s89, 80
    s_cselect_b32 s3, 5, 4
    s_cmp_ge_u32 s87, 63
    s_cselect_b32 s93, s3, s93
    v_perm_b32 v9, v212, v208, s35
    v_perm_b32 v13, v212, v208, s36
    v_perm_b32 v17, v213, v209, s35
    v_perm_b32 v21, v213, v209, s36
    v_perm_b32 v25, v214, v210, s35
    v_perm_b32 v29, v214, v210, s36
    v_perm_b32 v33, v215, v211, s35
    v_perm_b32 v37, v215, v211, s36
    s_waitcnt vmcnt(17)
    buffer_load_dwordx4 v[208:211], v2, s[24:27], s32 offen offset:2560 nt
    buffer_load_dwordx4 v[212:215], v2, s[24:27], s32 offen offset:2816 nt
    v_perm_b32 v10, v220, v216, s35
    v_perm_b32 v14, v220, v216, s36
    v_perm_b32 v18, v221, v217, s35
    v_perm_b32 v22, v221, v217, s36
    v_perm_b32 v26, v222, v218, s35
    v_perm_b32 v30, v222, v218, s36
    v_perm_b32 v34, v223, v219, s35
    v_perm_b32 v38, v223, v219, s36
    s_waitcnt vmcnt(17)
    buffer_load_dwordx4 v[216:219], v2, s[24:27], s32 offen offset:3072 nt
    buffer_load_dwordx4 v[220:223], v2, s[24:27], s32 offen offset:3328 nt
    v_perm_b32 v11, v228, v224, s35
    v_perm_b32 v15, v228, v224, s36
    v_perm_b32 v19, v229, v225, s35
    v_mfma_f32_16x16x32_bf16 v[40:43], v[8:11], v[100:103], v[40:43]
    v_perm_b32 v23, v229, v225, s36
    v_perm_b32 v27, v230, v226, s35
    v_mfma_f32_16x16x32_bf16 v[44:47], v[12:15], v[100:103], v[44:47]
    v_perm_b32 v31, v230, v226, s36
    v_perm_b32 v35, v231, v227, s35
    v_mfma_f32_16x16x32_bf16 v[48:51], v[16:19], v[100:103], v[48:51]
    v_perm_b32 v39, v231, v227, s36
    v_mfma_f32_16x16x32_bf16 v[52:55], v[20:23], v[100:103], v[52:55]
    s_waitcnt vmcnt(17)
    buffer_load_dwordx4 v[224:227], v2, s[24:27], s32 offen offset:3584 nt
    buffer_load_dwordx4 v[228:231], v2, s[24:27], s32 offen offset:3840 nt
    v_mfma_f32_16x16x32_bf16 v[56:59], v[24:27], v[100:103], v[56:59]
    v_mfma_f32_16x16x32_bf16 v[60:63], v[28:31], v[100:103], v[60:63]
    v_mfma_f32_16x16x32_bf16 v[64:67], v[32:35], v[100:103], v[64:67]
    v_mfma_f32_16x16x32_bf16 v[68:71], v[36:39], v[100:103], v[68:71]
    s_sub_u32 s38, s38, 1
    s_cbranch_scc1 L_k_done
    s_cmp_eq_u32 s93, 0
    s_cbranch_scc1 L_k0
    s_branch L_k_top
    .p2align 3
L_k2:
    s_add_u32 s34, s34, 1
    s_and_b32 s34, s34, 31
    s_and_b32 s3, s34, 3
    s_lshl_b32 s3, s3, 14
    s_lshr_b32 s32, s34, 2
    s_lshl_b32 s32, s32, 17
    s_or_b32 s32, s32, s3
    s_lshr_b32 s33, s32, 7
    s_add_u32 s39, s39, 1
    s_cmp_lg_u32 s39, 32
    s_cbranch_scc1 L_adv15
    s_add_u32 s24, s24, 2097152
    s_addc_u32 s25, s25, 0
    s_cmp_eq_u32 s51, 1
    s_cselect_b64 s[24:25], s[28:29], s[24:25]
    s_cselect_b64 s[20:21], s[12:13], s[20:21]
    s_mov_b32 s39, 0
    s_add_u32 s51, s51, 1
    s_cmp_ge_u32 s51, 4
    s_cselect_b32 s26, 0, s26
    s_cselect_b32 s22, 0, s22
L_adv15:
    s_waitcnt vmcnt(30)
    v_perm_b32 v8, v108, v104, s35
    v_perm_b32 v12, v108, v104, s36
    v_perm_b32 v16, v109, v105, s35
    v_perm_b32 v20, v109, v105, s36
    v_perm_b32 v24, v110, v106, s35
    v_perm_b32 v28, v110, v106, s36
    v_perm_b32 v32, v111, v107, s35
    v_perm_b32 v36, v111, v107, s36
    s_waitcnt vmcnt(21)
    buffer_load_dwordx4 v[88:91], v3, s[20:23], s33 offen offset:0
    buffer_load_dwordx4 v[92:95], v3, s[20:23], s33 offen offset:16
    buffer_load_dwordx4 v[96:99], v3, s[20:23], s33 offen offset:32
    buffer_load_dwordx4 v[100:103], v3, s[20:23], s33 offen offset:48
    buffer_load_dword v232, v233, s[96:99], 0 offen sc1
    buffer_load_dwordx4 v[104:107], v1, s[24:27], s32 offen offset:0 nt
    buffer_load_dwordx4 v[108:111], v1, s[24:27], s32 offen offset:256 nt
    s_cmp_lg_u32 s86, 1
    s_cbranch_scc1 L_nd16
    ds_write_b128 v4, v[40:43] offset:0
    ds_write_b128 v4, v[44:47] offset:1024
    ds_write_b128 v4, v[48:51] offset:2048
    ds_write_b128 v4, v[52:55] offset:3072
L_nd16:
    v_perm_b32 v9, v116, v112, s35
    v_perm_b32 v13, v116, v112, s36
    v_perm_b32 v17, v117, v113, s35
    v_perm_b32 v21, v117, v113, s36
    v_perm_b32 v25, v118, v114, s35
    v_perm_b32 v29, v118, v114, s36
    v_perm_b32 v33, v119, v115, s35
    v_perm_b32 v37, v119, v115, s36
    s_waitcnt vmcnt(26)
    buffer_load_dwordx4 v[112:115], v1, s[24:27], s32 offen offset:512 nt
    buffer_load_dwordx4 v[116:119], v1, s[24:27], s32 offen offset:768 nt
    s_cmp_lg_u32 s86, 1
    s_cbranch_scc1 L_nd17
    ds_write_b128 v4, v[56:59] offset:4096
    ds_write_b128 v4, v[60:63] offset:5120
    ds_write_b128 v4, v[64:67] offset:6144
    ds_write_b128 v4, v[68:71] offset:7168
    v_mov_b64 v[40:41], 0
    v_mov_b64 v[42:43], 0
    v_mov_b64 v[44:45], 0
    v_mov_b64 v[46:47], 0
    v_mov_b64 v[48:49], 0
    v_mov_b64 v[50:51], 0
    v_mov_b64 v[52:53], 0
    v_mov_b64 v[54:55], 0
L_nd17:
    v_perm_b32 v10, v124, v120, s35
    v_perm_b32 v14, v124, v120, s36
    v_perm_b32 v18, v125, v121, s35
    v_perm_b32 v22, v125, v121, s36
    v_perm_b32 v26, v126, v122, s35
    v_perm_b32 v30, v126, v122, s36
    v_perm_b32 v34, v127, v123, s35
    v_perm_b32 v38, v127, v123, s36
    s_waitcnt vmcnt(26)
    buffer_load_dwordx4 v[120:123], v1, s[24:27], s32 offen offset:1024 nt
    buffer_load_dwordx4 v[124:127], v1, s[24:27], s32 offen offset:1280 nt
    s_cmp_lg_u32 s86, 1
    s_cbranch_scc1 L_nd18
    v_mov_b64 v[56:57], 0
    v_mov_b64 v[58:59], 0
    v_mov_b64 v[60:61], 0
    v_mov_b64 v[62:63], 0
    v_mov_b64 v[64:65], 0
    v_mov_b64 v[66:67], 0
    v_mov_b64 v[68:69], 0
    v_mov_b64 v[70:71], 0
L_nd18:
    v_perm_b32 v11, v132, v128, s35
    v_perm_b32 v15, v132, v128, s36
    v_perm_b32 v19, v133, v129, s35
    v_mfma_f32_16x16x32_bf16 v[40:43], v[8:11], v[72:75], v[40:43]
    v_perm_b32 v23, v133, v129, s36
    v_perm_b32 v27, v134, v130, s35
    v_mfma_f32_16x16x32_bf16 v[44:47], v[12:15], v[72:75], v[44:47]
    v_perm_b32 v31, v134, v130, s36
    v_perm_b32 v35, v135, v131, s35
    v_mfma_f32_16x16x32_bf16 v[48:51], v[16:19], v[72:75], v[48:51]
    v_perm_b32 v39, v135, v131, s36
    v_mfma_f32_16x16x32_bf16 v[52:55], v[20:23], v[72:75], v[52:55]
    s_waitcnt vmcnt(26)
    buffer_load_dwordx4 v[128:131], v1, s[24:27], s32 offen offset:1536 nt
    buffer_load_dwordx4 v[132:135], v1, s[24:27], s32 offen offset:1792 nt
    v_mfma_f32_16x16x32_bf16 v[56:59], v[24:27], v[72:75], v[56:59]
    v_perm_b32 v8, v140, v136, s35
    v_perm_b32 v12, v140, v136, s36
    v_mfma_f32_16x16x32_bf16 v[60:63], v[28:31], v[72:75], v[60:63]
    v_perm_b32 v16, v141, v137, s35
    v_perm_b32 v20, v141, v137, s36
    v_mfma_f32_16x16x32_bf16 v[64:67], v[32:35], v[72:75], v[64:67]
    v_perm_b32 v24, v142, v138, s35
    v_perm_b32 v28, v142, v138, s36
    v_mfma_f32_16x16x32_bf16 v[68:71], v[36:39], v[72:75], v[68:71]
    v_perm_b32 v32, v143, v139, s35
    v_perm_b32 v36, v143, v139, s36
    s_waitcnt vmcnt(26)
    buffer_load_dwordx4 v[136:139], v1, s[24:27], s32 offen offset:2048 nt
    buffer_load_dwordx4 v[140:143], v1, s[24:27], s32 offen offset:2304 nt
    v_perm_b32 v9, v148, v144, s35
    v_perm_b32 v13, v148, v144, s36
    v_perm_b32 v17, v149, v145, s35
    v_perm_b32 v21, v149, v145, s36
    v_perm_b32 v25, v150, v146, s35
    v_perm_b32 v29, v150, v146, s36
    v_perm_b32 v33, v151, v147, s35
    v_perm_b32 v37, v151, v147, s36
    s_waitcnt vmcnt(26)
    buffer_load_dwordx4 v[144:147], v1, s[24:27], s32 offen offset:2560 nt
    buffer_load_dwordx4 v[148:151], v1, s[24:27], s32 offen offset:2816 nt
    v_perm_b32 v10, v156, v152, s35
    v_perm_b32 v14, v156, v152, s36
    v_perm_b32 v18, v157, v153, s35
    v_perm_b32 v22, v157, v153, s36
    v_perm_b32 v26, v158, v154, s35
    v_perm_b32 v30, v158, v154, s36
    v_perm_b32 v34, v159, v155, s35
    v_perm_b32 v38, v159, v155, s36
    s_waitcnt vmcnt(26)
    buffer_load_dwordx4 v[152:155], v1, s[24:27], s32 offen offset:3072 nt
    buffer_load_dwordx4 v[156:159], v1, s[24:27], s32 offen offset:3328 nt
    v_perm_b32 v11, v164, v160, s35
    v_perm_b32 v15, v164, v160, s36
    v_perm_b32 v19, v165, v161, s35
    v_mfma_f32_16x16x32_bf16 v[40:43], v[8:11], v[76:79], v[40:43]
    v_perm_b32 v23, v165, v161, s36
    v_perm_b32 v27, v166, v162, s35
    v_mfma_f32_16x16x32_bf16 v[44:47], v[12:15], v[76:79], v[44:47]
    v_perm_b32 v31, v166, v162, s36
    v_perm_b32 v35, v167, v163, s35
    v_mfma_f32_16x16x32_bf16 v[48:51], v[16:19], v[76:79], v[48:51]
    v_perm_b32 v39, v167, v163, s36
    v_mfma_f32_16x16x32_bf16 v[52:55], v[20:23], v[76:79], v[52:55]
    s_waitcnt vmcnt(26)
    buffer_load_dwordx4 v[160:163], v1, s[24:27], s32 offen offset:3584 nt
    buffer_load_dwordx4 v[164:167], v1, s[24:27], s32 offen offset:3840 nt
    v_mfma_f32_16x16x32_bf16 v[56:59], v[24:27], v[76:79], v[56:59]
    v_perm_b32 v8, v172, v168, s35
    v_perm_b32 v12, v172, v168, s36
    v_mfma_f32_16x16x32_bf16 v[60:63], v[28:31], v[76:79], v[60:63]
    v_perm_b32 v16, v173, v169, s35
    v_perm_b32 v20, v173, v169, s36
    v_mfma_f32_16x16x32_bf16 v[64:67], v[32:35], v[76:79], v[64:67]
    v_perm_b32 v24, v174, v170, s35
    v_perm_b32 v28, v174, v170, s36
    v_mfma_f32_16x16x32_bf16 v[68:71], v[36:39], v[76:79], v[68:71]
    v_perm_b32 v32, v175, v171, s35
    v_perm_b32 v36, v175, v171, s36
    s_waitcnt vmcnt(26)
    buffer_load_dwordx4 v[168:171], v2, s[24:27], s32 offen offset:0 nt
    buffer_load_dwordx4 v[172:175], v2, s[24:27], s32 offen offset:256 nt
    v_perm_b32 v9, v180, v176, s35
    v_perm_b32 v13, v180, v176, s36
    v_perm_b32 v17, v181, v177, s35
    v_perm_b32 v21, v181, v177, s36
    v_perm_b32 v25, v182, v178, s35
    v_perm_b32 v29, v182, v178, s36
    v_perm_b32 v33, v183, v179, s35
    v_perm_b32 v37, v183, v179, s36
    s_waitcnt vmcnt(26)
    buffer_load_dwordx4 v[176:179], v2, s[24:27], s32 offen offset:512 nt
    buffer_load_dwordx4 v[180:183], v2, s[24:27], s32 offen offset:768 nt
    v_perm_b32 v10, v188, v184, s35
    v_perm_b32 v14, v188, v184, s36
    v_perm_b32 v18, v189, v185, s35
    v_perm_b32 v22, v189, v185, s36
    v_perm_b32 v26, v190, v186, s35
    v_perm_b32 v30, v190, v186, s36
    v_perm_b32 v34, v191, v187, s35
    v_perm_b32 v38, v191, v187, s36
    s_waitcnt vmcnt(26)
    buffer_load_dwordx4 v[184:187], v2, s[24:27], s32 offen offset:1024 nt
    buffer_load_dwordx4 v[188:191], v2, s[24:27], s32 offen offset:1280 nt
    v_perm_b32 v11, v196, v192, s35
    v_perm_b32 v15, v196, v192, s36
    v_perm_b32 v19, v197, v193, s35
    v_mfma_f32_16x16x32_bf16 v[40:43], v[8:11], v[80:83], v[40:43]
    v_perm_b32 v23, v197, v193, s36
    v_perm_b32 v27, v198, v194, s35
    v_mfma_f32_16x16x32_bf16 v[44:47], v[12:15], v[80:83], v[44:47]
    v_perm_b32 v31, v198, v194, s36
    v_perm_b32 v35, v199, v195, s35
    v_mfma_f32_16x16x32_bf16 v[48:51], v[16:19], v[80:83], v[48:51]
    v_perm_b32 v39, v199, v195, s36
    v_mfma_f32_16x16x32_bf16 v[52:55], v[20:23], v[80:83], v[52:55]
    s_waitcnt vmcnt(21)
    buffer_load_dwordx4 v[192:195], v2, s[24:27], s32 offen offset:1536 nt
    buffer_load_dwordx4 v[196:199], v2, s[24:27], s32 offen offset:1792 nt
    v_mfma_f32_16x16x32_bf16 v[56:59], v[24:27], v[80:83], v[56:59]
    v_perm_b32 v8, v204, v200, s35
    v_perm_b32 v12, v204, v200, s36
    v_mfma_f32_16x16x32_bf16 v[60:63], v[28:31], v[80:83], v[60:63]
    v_perm_b32 v16, v205, v201, s35
    v_perm_b32 v20, v205, v201, s36
    v_mfma_f32_16x16x32_bf16 v[64:67], v[32:35], v[80:83], v[64:67]
    v_perm_b32 v24, v206, v202, s35
    v_perm_b32 v28, v206, v202, s36
    v_mfma_f32_16x16x32_bf16 v[68:71], v[36:39], v[80:83], v[68:71]
    v_perm_b32 v32, v207, v203, s35
    v_perm_b32 v36, v207, v203, s36
    s_waitcnt vmcnt(21)
    buffer_load_dwordx4 v[200:203], v2, s[24:27], s32 offen offset:2048 nt
    buffer_load_dwordx4 v[204:207], v2, s[24:27], s32 offen offset:2304 nt
    v_perm_b32 v9, v212, v208, s35
    v_perm_b32 v13, v212, v208, s36
    v_perm_b32 v17, v213, v209, s35
    v_perm_b32 v21, v213, v209, s36
    v_perm_b32 v25, v214, v210, s35
    v_perm_b32 v29, v214, v210, s36
    v_perm_b32 v33, v215, v211, s35
    v_perm_b32 v37, v215, v211, s36
    s_waitcnt vmcnt(21)
    buffer_load_dwordx4 v[208:211], v2, s[24:27], s32 offen offset:2560 nt
    buffer_load_dwordx4 v[212:215], v2, s[24:27], s32 offen offset:2816 nt
    v_perm_b32 v10, v220, v216, s35
    v_perm_b32 v14, v220, v216, s36
    v_perm_b32 v18, v221, v217, s35
    v_perm_b32 v22, v221, v217, s36
    v_perm_b32 v26, v222, v218, s35
    v_perm_b32 v30, v222, v218, s36
    v_perm_b32 v34, v223, v219, s35
    v_perm_b32 v38, v223, v219, s36
    s_waitcnt vmcnt(21)
    buffer_load_dwordx4 v[216:219], v2, s[24:27], s32 offen offset:3072 nt
    buffer_load_dwordx4 v[220:223], v2, s[24:27], s32 offen offset:3328 nt
    v_perm_b32 v11, v228, v224, s35
    v_perm_b32 v15, v228, v224, s36
    v_perm_b32 v19, v229, v225, s35
    v_mfma_f32_16x16x32_bf16 v[40:43], v[8:11], v[84:87], v[40:43]
    v_perm_b32 v23, v229, v225, s36
    v_perm_b32 v27, v230, v226, s35
    v_mfma_f32_16x16x32_bf16 v[44:47], v[12:15], v[84:87], v[44:47]
    v_perm_b32 v31, v230, v226, s36
    v_perm_b32 v35, v231, v227, s35
    v_mfma_f32_16x16x32_bf16 v[48:51], v[16:19], v[84:87], v[48:51]
    v_perm_b32 v39, v231, v227, s36
    v_mfma_f32_16x16x32_bf16 v[52:55], v[20:23], v[84:87], v[52:55]
    s_waitcnt vmcnt(21)
    buffer_load_dwordx4 v[224:227], v2, s[24:27], s32 offen offset:3584 nt
    buffer_load_dwordx4 v[228:231], v2, s[24:27], s32 offen offset:3840 nt
    s_add_u32 s34, s34, 1
    s_and_b32 s34, s34, 31
    s_and_b32 s3, s34, 3
    s_lshl_b32 s3, s3, 14
    s_lshr_b32 s32, s34, 2
    s_lshl_b32 s32, s32, 17
    s_or_b32 s32, s32, s3
    s_lshr_b32 s33, s32, 7
    s_add_u32 s39, s39, 1
    s_cmp_lg_u32 s39, 32
    s_cbranch_scc1 L_adv19
    s_add_u32 s24, s24, 2097152
    s_addc_u32 s25, s25, 0
    s_cmp_eq_u32 s51, 1
    s_cselect_b64 s[24:25], s[28:29], s[24:25]
    s_cselect_b64 s[20:21], s[12:13], s[20:21]
    s_mov_b32 s39, 0
    s_add_u32 s51, s51, 1
    s_cmp_ge_u32 s51, 4
    s_cselect_b32 s26, 0, s26
    s_cselect_b32 s22, 0, s22
L_adv19:
    s_cmp_eq_u32 s86, 0
    s_cbranch_scc1 L_np20
    s_mov_b32 s86, 0
    s_waitcnt lgkmcnt(0)
    s_barrier
L_np20:
    v_mfma_f32_16x16x32_bf16 v[56:59], v[24:27], v[84:87], v[56:59]
    v_perm_b32 v8, v108, v104, s35
    v_perm_b32 v12, v108, v104, s36
    v_mfma_f32_16x16x32_bf16 v[60:63], v[28:31], v[84:87], v[60:63]
    v_perm_b32 v16, v109, v105, s35
    v_perm_b32 v20, v109, v105, s36
    v_mfma_f32_16x16x32_bf16 v[64:67], v[32:35], v[84:87], v[64:67]
    v_perm_b32 v24, v110, v106, s35
    v_perm_b32 v28, v110, v106, s36
    v_mfma_f32_16x16x32_bf16 v[68:71], v[36:39], v[84:87], v[68:71]
    v_perm_b32 v32, v111, v107, s35
    v_perm_b32 v36, v111, v107, s36
    s_waitcnt vmcnt(21)
    buffer_load_dwordx4 v[72:75], v3, s[20:23], s33 offen offset:0
    buffer_load_dwordx4 v[76:79], v3, s[20:23], s33 offen offset:16
    buffer_load_dwordx4 v[80:83], v3, s[20:23], s33 offen offset:32
    buffer_load_dwordx4 v[84:87], v3, s[20:23], s33 offen offset:48
    buffer_load_dwordx4 v[104:107], v1, s[24:27], s32 offen offset:0 nt
    buffer_load_dwordx4 v[108:111], v1, s[24:27], s32 offen offset:256 nt
    v_perm_b32 v9, v116, v112, s35
    v_perm_b32 v13, v116, v112, s36
    v_perm_b32 v17, v117, v113, s35
    v_perm_b32 v21, v117, v113, s36
    v_perm_b32 v25, v118, v114, s35
    v_perm_b32 v29, v118, v114, s36
    v_perm_b32 v33, v119, v115, s35
    v_perm_b32 v37, v119, v115, s36
    s_waitcnt vmcnt(25)
    buffer_load_dwordx4 v[112:115], v1, s[24:27], s32 offen offset:512 nt
    buffer_load_dwordx4 v[116:119], v1, s[24:27], s32 offen offset:768 nt
    v_perm_b32 v10, v124, v120, s35
    v_perm_b32 v14, v124, v120, s36
    v_perm_b32 v18, v125, v121, s35
    v_perm_b32 v22, v125, v121, s36
    v_perm_b32 v26, v126, v122, s35
    v_perm_b32 v30, v126, v122, s36
    v_perm_b32 v34, v127, v123, s35
    v_perm_b32 v38, v127, v123, s36
    s_waitcnt vmcnt(25)
    buffer_load_dwordx4 v[120:123], v1, s[24:27], s32 offen offset:1024 nt
    buffer_load_dwordx4 v[124:127], v1, s[24:27], s32 offen offset:1280 nt
    v_perm_b32 v11, v132, v128, s35
    v_perm_b32 v15, v132, v128, s36
    v_perm_b32 v19, v133, v129, s35
    v_mfma_f32_16x16x32_bf16 v[40:43], v[8:11], v[88:91], v[40:43]
    v_perm_b32 v23, v133, v129, s36
    v_perm_b32 v27, v134, v130, s35
    v_mfma_f32_16x16x32_bf16 v[44:47], v[12:15], v[88:91], v[44:47]
    v_perm_b32 v31, v134, v130, s36
    v_perm_b32 v35, v135, v131, s35
    v_mfma_f32_16x16x32_bf16 v[48:51], v[16:19], v[88:91], v[48:51]
    v_perm_b32 v39, v135, v131, s36
    v_mfma_f32_16x16x32_bf16 v[52:55], v[20:23], v[88:91], v[52:55]
    s_waitcnt vmcnt(25)
    buffer_load_dwordx4 v[128:131], v1, s[24:27], s32 offen offset:1536 nt
    buffer_load_dwordx4 v[132:135], v1, s[24:27], s32 offen offset:1792 nt
    v_mfma_f32_16x16x32_bf16 v[56:59], v[24:27], v[88:91], v[56:59]
    v_perm_b32 v8, v140, v136, s35
    v_perm_b32 v12, v140, v136, s36
    v_mfma_f32_16x16x32_bf16 v[60:63], v[28:31], v[88:91], v[60:63]
    v_perm_b32 v16, v141, v137, s35
    v_perm_b32 v20, v141, v137, s36
    v_mfma_f32_16x16x32_bf16 v[64:67], v[32:35], v[88:91], v[64:67]
    v_perm_b32 v24, v142, v138, s35
    v_perm_b32 v28, v142, v138, s36
    v_mfma_f32_16x16x32_bf16 v[68:71], v[36:39], v[88:91], v[68:71]
    v_perm_b32 v32, v143, v139, s35
    v_perm_b32 v36, v143, v139, s36
    s_waitcnt vmcnt(25)
    buffer_load_dwordx4 v[136:139], v1, s[24:27], s32 offen offset:2048 nt
    buffer_load_dwordx4 v[140:143], v1, s[24:27], s32 offen offset:2304 nt
    v_perm_b32 v9, v148, v144, s35
    v_perm_b32 v13, v148, v144, s36
    v_perm_b32 v17, v149, v145, s35
    v_perm_b32 v21, v149, v145, s36
    v_perm_b32 v25, v150, v146, s35
    v_perm_b32 v29, v150, v146, s36
    v_perm_b32 v33, v151, v147, s35
    v_perm_b32 v37, v151, v147, s36
    s_waitcnt vmcnt(25)
    buffer_load_dwordx4 v[144:147], v1, s[24:27], s32 offen offset:2560 nt
    buffer_load_dwordx4 v[148:151], v1, s[24:27], s32 offen offset:2816 nt
    s_memrealtime s[80:81]
    s_add_u32 s87, s87, 1
    s_add_u32 s82, s82, 1721
    v_readlane_b32 s85, v232, s84
    v_perm_b32 v10, v156, v152, s35
    v_perm_b32 v14, v156, v152, s36
    v_perm_b32 v18, v157, v153, s35
    v_perm_b32 v22, v157, v153, s36
    v_perm_b32 v26, v158, v154, s35
    v_perm_b32 v30, v158, v154, s36
    v_perm_b32 v34, v159, v155, s35
    v_perm_b32 v38, v159, v155, s36
    s_waitcnt vmcnt(25)
    buffer_load_dwordx4 v[152:155], v1, s[24:27], s32 offen offset:3072 nt
    buffer_load_dwordx4 v[156:159], v1, s[24:27], s32 offen offset:3328 nt
    v_perm_b32 v11, v164, v160, s35
    v_perm_b32 v15, v164, v160, s36
    v_perm_b32 v19, v165, v161, s35
    v_mfma_f32_16x16x32_bf16 v[40:43], v[8:11], v[92:95], v[40:43]
    v_perm_b32 v23, v165, v161, s36
    v_perm_b32 v27, v166, v162, s35
    v_mfma_f32_16x16x32_bf16 v[44:47], v[12:15], v[92:95], v[44:47]
    v_perm_b32 v31, v166, v162, s36
    v_perm_b32 v35, v167, v163, s35
    v_mfma_f32_16x16x32_bf16 v[48:51], v[16:19], v[92:95], v[48:51]
    v_perm_b32 v39, v167, v163, s36
    v_mfma_f32_16x16x32_bf16 v[52:55], v[20:23], v[92:95], v[52:55]
    s_waitcnt vmcnt(25)
    buffer_load_dwordx4 v[160:163], v1, s[24:27], s32 offen offset:3584 nt
    buffer_load_dwordx4 v[164:167], v1, s[24:27], s32 offen offset:3840 nt
    v_mfma_f32_16x16x32_bf16 v[56:59], v[24:27], v[92:95], v[56:59]
    v_perm_b32 v8, v172, v168, s35
    v_perm_b32 v12, v172, v168, s36
    v_mfma_f32_16x16x32_bf16 v[60:63], v[28:31], v[92:95], v[60:63]
    v_perm_b32 v16, v173, v169, s35
    v_perm_b32 v20, v173, v169, s36
    v_mfma_f32_16x16x32_bf16 v[64:67], v[32:35], v[92:95], v[64:67]
    v_perm_b32 v24, v174, v170, s35
    v_perm_b32 v28, v174, v170, s36
    v_mfma_f32_16x16x32_bf16 v[68:71], v[36:39], v[92:95], v[68:71]
    v_perm_b32 v32, v175, v171, s35
    v_perm_b32 v36, v175, v171, s36
    s_waitcnt vmcnt(25)
    buffer_load_dwordx4 v[168:171], v2, s[24:27], s32 offen offset:0 nt
    buffer_load_dwordx4 v[172:175], v2, s[24:27], s32 offen offset:256 nt
    s_bfe_u32 s58, s85, 0x180003
    s_lshr_b32 s3, s85, 28
    s_cmp_eq_u32 s3, 8
    s_cselect_b32 s83, s58, s83
    s_cselect_b32 s98, 0, s98
    s_cselect_b32 s77, s76, s77
    s_addc_u32 s84, s84, 0
    s_bitcmp1_b64 s[94:95], s87
    s_cselect_b32 s98, 64, s98
    v_perm_b32 v9, v180, v176, s35
    v_perm_b32 v13, v180, v176, s36
    v_perm_b32 v17, v181, v177, s35
    v_perm_b32 v21, v181, v177, s36
    v_perm_b32 v25, v182, v178, s35
    v_perm_b32 v29, v182, v178, s36
    v_perm_b32 v33, v183, v179, s35
    v_perm_b32 v37, v183, v179, s36
    s_waitcnt vmcnt(25)
    buffer_load_dwordx4 v[176:179], v2, s[24:27], s32 offen offset:512 nt
    buffer_load_dwordx4 v[180:183], v2, s[24:27], s32 offen offset:768 nt
    s_lshr_b32 s3, s82, 3
    s_waitcnt lgkmcnt(0)
    s_sub_u32 s80, s80, s3
    s_sub_u32 s3, s80, s40
    s_mov_b32 s40, s80
    s_cmp_gt_i32 s3, 110
    s_cselect_b32 s3, s3, 0
    s_add_u32 s77, s77, s3
    s_add_u32 s76, s76, s3
    s_bitcmp1_b64 s[100:101], s87
    s_cselect_b32 s76, 0, s76
    s_sub_u32 s89, s80, s77
    s_sub_u32 s89, s89, s83
    s_bfe_i32 s89, s89, 0x180000
    s_bitcmp0_b64 s[90:91], s87
    s_cbranch_scc1 L_rp21
    s_and_b32 s92, s80, 0xffffff
    s_or_b32 s92, s92, 0x10000000
    s_atomic_add s92, s[78:79], s88
    s_add_u32 s88, s88, 4
L_rp21:
    v_perm_b32 v10, v188, v184, s35
    v_perm_b32 v14, v188, v184, s36
    v_perm_b32 v18, v189, v185, s35
    v_perm_b32 v22, v189, v185, s36
    v_perm_b32 v26, v190, v186, s35
    v_perm_b32 v30, v190, v186, s36
    v_perm_b32 v34, v191, v187, s35
    v_perm_b32 v38, v191, v187, s36
    s_waitcnt vmcnt(25)
    buffer_load_dwordx4 v[184:187], v2, s[24:27], s32 offen offset:1024 nt
    buffer_load_dwordx4 v[188:191], v2, s[24:27], s32 offen offset:1280 nt
    v_perm_b32 v11, v196, v192, s35
    v_perm_b32 v15, v196, v192, s36
    v_perm_b32 v19, v197, v193, s35
    v_mfma_f32_16x16x32_bf16 v[40:43], v[8:11], v[96:99], v[40:43]
    v_perm_b32 v23, v197, v193, s36
    v_perm_b32 v27, v198, v194, s35
    v_mfma_f32_16x16x32_bf16 v[44:47], v[12:15], v[96:99], v[44:47]
    v_perm_b32 v31, v198, v194, s36
    v_perm_b32 v35, v199, v195, s35
    v_mfma_f32_16x16x32_bf16 v[48:51], v[16:19], v[96:99], v[48:51]
    v_perm_b32 v39, v199, v195, s36
    v_mfma_f32_16x16x32_bf16 v[52:55], v[20:23], v[96:99], v[52:55]
    s_waitcnt vmcnt(21)
    buffer_load_dwordx4 v[192:195], v2, s[24:27], s32 offen offset:1536 nt
    buffer_load_dwordx4 v[196:199], v2, s[24:27], s32 offen offset:1792 nt
    v_mfma_f32_16x16x32_bf16 v[56:59], v[24:27], v[96:99], v[56:59]
    v_perm_b32 v8, v204, v200, s35
    v_perm_b32 v12, v204, v200, s36
    v_mfma_f32_16x16x32_bf16 v[60:63], v[28:31], v[96:99], v[60:63]
    v_perm_b32 v16, v205, v201, s35
    v_perm_b32 v20, v205, v201, s36
    v_mfma_f32_16x16x32_bf16 v[64:67], v[32:35], v[96:99], v[64:67]
    v_perm_b32 v24, v206, v202, s35
    v_perm_b32 v28, v206, v202, s36
    v_mfma_f32_16x16x32_bf16 v[68:71], v[36:39], v[96:99], v[68:71]
    v_perm_b32 v32, v207, v203, s35
    v_perm_b32 v36, v207, v203, s36
    s_waitcnt vmcnt(21)
    buffer_load_dwordx4 v[200:203], v2, s[24:27], s32 offen offset:2048 nt
    buffer_load_dwordx4 v[204:207], v2, s[24:27], s32 offen offset:2304 nt
    s_mov_b32 s93, 0
    s_cmp_ge_u32 s87, 52
    s_cselect_b32 s3, 1, 0
    s_lshl_b32 s89, s89, s3
    s_cmp_ge_i32 s89, -80
    s_addc_u32 s93, s93, 0
    s_cmp_ge_i32 s89, 80
    s_addc_u32 s93, s93, 0
    s_cmp_ge_i32 s89, 250
    s_addc_u32 s93, s93, 0
    s_cmp_eq_u32 s83, -1
    s_cselect_b32 s93, 1, s93
    s_cmp_lt_i32 s89, 80
    s_cselect_b32 s3, 5, 4
    s_cmp_ge_u32 s87, 63
    s_cselect_b32 s93, s3, s93
    v_perm_b32 v9, v212, v208, s35
    v_perm_b32 v13, v212, v208, s36
    v_perm_b32 v17, v213, v209, s35
    v_perm_b32 v21, v213, v209, s36
    v_perm_b32 v25, v214, v210, s35
    v_perm_b32 v29, v214, v210, s36
    v_perm_b32 v33, v215, v211, s35
    v_perm_b32 v37, v215, v211, s36
    s_waitcnt vmcnt(21)
    buffer_load_dwordx4 v[208:211], v2, s[24:27], s32 offen offset:2560 nt
    buffer_load_dwordx4 v[212:215], v2, s[24:27], s32 offen offset:2816 nt
    v_perm_b32 v10, v220, v216, s35
    v_perm_b32 v14, v220, v216, s36
    v_perm_b32 v18, v221, v217, s35
    v_perm_b32 v22, v221, v217, s36
    v_perm_b32 v26, v222, v218, s35
    v_perm_b32 v30, v222, v218, s36
    v_perm_b32 v34, v223, v219, s35
    v_perm_b32 v38, v223, v219, s36
    s_waitcnt vmcnt(21)
    buffer_load_dwordx4 v[216:219], v2, s[24:27], s32 offen offset:3072 nt
    buffer_load_dwordx4 v[220:223], v2, s[24:27], s32 offen offset:3328 nt
    v_perm_b32 v11, v228, v224, s35
    v_perm_b32 v15, v228, v224, s36
    v_perm_b32 v19, v229, v225, s35
    v_mfma_f32_16x16x32_bf16 v[40:43], v[8:11], v[100:103], v[40:43]
    v_perm_b32 v23, v229, v225, s36
    v_perm_b32 v27, v230, v226, s35
    v_mfma_f32_16x16x32_bf16 v[44:47], v[12:15], v[100:103], v[44:47]
    v_perm_b32 v31, v230, v226, s36
    v_perm_b32 v35, v231, v227, s35
    v_mfma_f32_16x16x32_bf16 v[48:51], v[16:19], v[100:103], v[48:51]
    v_perm_b32 v39, v231, v227, s36
    v_mfma_f32_16x16x32_bf16 v[52:55], v[20:23], v[100:103], v[52:55]
    s_waitcnt vmcnt(21)
    buffer_load_dwordx4 v[224:227], v2, s[24:27], s32 offen offset:3584 nt
    buffer_load_dwordx4 v[228:231], v2, s[24:27], s32 offen offset:3840 nt
    v_mfma_f32_16x16x32_bf16 v[56:59], v[24:27], v[100:103], v[56:59]
    v_mfma_f32_16x16x32_bf16 v[60:63], v[28:31], v[100:103], v[60:63]
    v_mfma_f32_16x16x32_bf16 v[64:67], v[32:35], v[100:103], v[64:67]
    v_mfma_f32_16x16x32_bf16 v[68:71], v[36:39], v[100:103], v[68:71]
    s_sub_u32 s38, s38, 1
    s_cbranch_scc1 L_k_done
    s_cmp_eq_u32 s93, 2
    s_cbranch_scc1 L_k2
    s_branch L_k_top
    .p2align 3
L_k3:
    s_add_u32 s34, s34, 1
    s_and_b32 s34, s34, 31
    s_and_b32 s3, s34, 3
    s_lshl_b32 s3, s3, 14
    s_lshr_b32 s32, s34, 2
    s_lshl_b32 s32, s32, 17
    s_or_b32 s32, s32, s3
    s_lshr_b32 s33, s32, 7
    s_add_u32 s39, s39, 1
    s_cmp_lg_u32 s39, 32
    s_cbranch_scc1 L_adv22
    s_add_u32 s24, s24, 2097152
    s_addc_u32 s25, s25, 0
    s_cmp_eq_u32 s51, 1
    s_cselect_b64 s[24:25], s[28:29], s[24:25]
    s_cselect_b64 s[20:21], s[12:13], s[20:21]
    s_mov_b32 s39, 0
    s_add_u32 s51, s51, 1
    s_cmp_ge_u32 s51, 4
    s_cselect_b32 s26, 0, s26
    s_cselect_b32 s22, 0, s22
L_adv22:
    s_waitcnt vmcnt(30)
    v_perm_b32 v8, v108, v104, s35
    v_perm_b32 v12, v108, v104, s36
    v_perm_b32 v16, v109, v105, s35
    v_perm_b32 v20, v109, v105, s36
    v_perm_b32 v24, v110, v106, s35
    v_perm_b32 v28, v110, v106, s36
    v_perm_b32 v32, v111, v107, s35
    v_perm_b32 v36, v111, v107, s36
    s_waitcnt vmcnt(25)
    buffer_load_dwordx4 v[88:91], v3, s[20:23], s33 offen offset:0
    buffer_load_dwordx4 v[92:95], v3, s[20:23], s33 offen offset:16
    buffer_load_dwordx4 v[96:99], v3, s[20:23], s33 offen offset:32
    buffer_load_dwordx4 v[100:103], v3, s[20:23], s33 offen offset:48
    buffer_load_dword v232, v233, s[96:99], 0 offen sc1
    buffer_load_dwordx4 v[104:107], v1, s[24:27], s32 offen offset:0 nt
    buffer_load_dwordx4 v[108:111], v1, s[24:27], s32 offen offset:256 nt
    s_cmp_lg_u32 s86, 1
    s_cbranch_scc1 L_nd23
    ds_write_b128 v4, v[40:43] offset:0
    ds_write_b128 v4, v[44:47] offset:1024
    ds_write_b128 v4, v[48:51] offset:2048
    ds_write_b128 v4, v[52:55] offset:3072
L_nd23:
    v_perm_b32 v9, v116, v112, s35
    v_perm_b32 v13, v116, v112, s36
    v_perm_b32 v17, v117, v113, s35
    v_perm_b32 v21, v117, v113, s36
    v_perm_b32 v25, v118, v114, s35
    v_perm_b32 v29, v118, v114, s36
    v_perm_b32 v33, v119, v115, s35
    v_perm_b32 v37, v119, v115, s36
    s_waitcnt vmcnt(30)
    buffer_load_dwordx4 v[112:115], v1, s[24:27], s32 offen offset:512 nt
    buffer_load_dwordx4 v[116:119], v1, s[24:27], s32 offen offset:768 nt
    s_cmp_lg_u32 s86, 1
    s_cbranch_scc1 L_nd24
    ds_write_b128 v4, v[56:59] offset:4096
    ds_write_b128 v4, v[60:63] offset:5120
    ds_write_b128 v4, v[64:67] offset:6144
    ds_write_b128 v4, v[68:71] offset:7168
    v_mov_b64 v[40:41], 0
    v_mov_b64 v[42:43], 0
    v_mov_b64 v[44:45], 0
    v_mov_b64 v[46:47], 0
    v_mov_b64 v[48:49], 0
    v_mov_b64 v[50:51], 0
    v_mov_b64 v[52:53], 0
    v_mov_b64 v[54:55], 0
L_nd24:
    v_perm_b32 v10, v124, v120, s35
    v_perm_b32 v14, v124, v120, s36
    v_perm_b32 v18, v125, v121, s35
    v_perm_b32 v22, v125, v121, s36
    v_perm_b32 v26, v126, v122, s35
    v_perm_b32 v30, v126, v122, s36
    v_perm_b32 v34, v127, v123, s35
    v_perm_b32 v38, v127, v123, s36
    s_waitcnt vmcnt(30)
    buffer_load_dwordx4 v[120:123], v1, s[24:27], s32 offen offset:1024 nt
    buffer_load_dwordx4 v[124:127], v1, s[24:27], s32 offen offset:1280 nt
    s_cmp_lg_u32 s86, 1
    s_cbranch_scc1 L_nd25
    v_mov_b64 v[56:57], 0
    v_mov_b64 v[58:59], 0
    v_mov_b64 v[60:61], 0
    v_mov_b64 v[62:63], 0
    v_mov_b64 v[64:65], 0
    v_mov_b64 v[66:67], 0
    v_mov_b64 v[68:69], 0
    v_mov_b64 v[70:71], 0
L_nd25:
    v_perm_b32 v11, v132, v128, s35
    v_perm_b32 v15, v132, v128, s36
    v_perm_b32 v19, v133, v129, s35
    v_mfma_f32_16x16x32_bf16 v[40:43], v[8:11], v[72:75], v[40:43]
    v_perm_b32 v23, v133, v129, s36
    v_perm_b32 v27, v134, v130, s35
    v_mfma_f32_16x16x32_bf16 v[44:47], v[12:15], v[72:75], v[44:47]
    v_perm_b32 v31, v134, v130, s36
    v_perm_b32 v35, v135, v131, s35
    v_mfma_f32_16x16x32_bf16 v[48:51], v[16:19], v[72:75], v[48:51]
    v_perm_b32 v39, v135, v131, s36
    v_mfma_f32_16x16x32_bf16 v[52:55], v[20:23], v[72:75], v[52:55]
    s_waitcnt vmcnt(30)
    buffer_load_dwordx4 v[128:131], v1, s[24:27], s32 offen offset:1536 nt
    buffer_load_dwordx4 v[132:135], v1, s[24:27], s32 offen offset:1792 nt
    v_mfma_f32_16x16x32_bf16 v[56:59], v[24:27], v[72:75], v[56:59]
    v_perm_b32 v8, v140, v136, s35
    v_perm_b32 v12, v140, v136, s36
    v_mfma_f32_16x16x32_bf16 v[60:63], v[28:31], v[72:75], v[60:63]
    v_perm_b32 v16, v141, v137, s35
    v_perm_b32 v20, v141, v137, s36
    v_mfma_f32_16x16x32_bf16 v[64:67], v[32:35], v[72:75], v[64:67]
    v_perm_b32 v24, v142, v138, s35
    v_perm_b32 v28, v142, v138, s36
    v_mfma_f32_16x16x32_bf16 v[68:71], v[36:39], v[72:75], v[68:71]
    v_perm_b32 v32, v143, v139, s35
    v_perm_b32 v36, v143, v139, s36
    s_waitcnt vmcnt(30)
    buffer_load_dwordx4 v[136:139], v1, s[24:27], s32 offen offset:2048 nt
    buffer_load_dwordx4 v[140:143], v1, s[24:27], s32 offen offset:2304 nt
    v_perm_b32 v9, v148, v144, s35
    v_perm_b32 v13, v148, v144, s36
    v_perm_b32 v17, v149, v145, s35
    v_perm_b32 v21, v149, v145, s36
    v_perm_b32 v25, v150, v146, s35
    v_perm_b32 v29, v150, v146, s36
    v_perm_b32 v33, v151, v147, s35
    v_perm_b32 v37, v151, v147, s36
    s_waitcnt vmcnt(30)
    buffer_load_dwordx4 v[144:147], v1, s[24:27], s32 offen offset:2560 nt
    buffer_load_dwordx4 v[148:151], v1, s[24:27], s32 offen offset:2816 nt
    v_perm_b32 v10, v156, v152, s35
    v_perm_b32 v14, v156, v152, s36
    v_perm_b32 v18, v157, v153, s35
    v_perm_b32 v22, v157, v153, s36
    v_perm_b32 v26, v158, v154, s35
    v_perm_b32 v30, v158, v154, s36
    v_perm_b32 v34, v159, v155, s35
    v_perm_b32 v38, v159, v155, s36
    s_waitcnt vmcnt(30)
    buffer_load_dwordx4 v[152:155], v1, s[24:27], s32 offen offset:3072 nt
    buffer_load_dwordx4 v[156:159], v1, s[24:27], s32 offen offset:3328 nt
    v_perm_b32 v11, v164, v160, s35
    v_perm_b32 v15, v164, v160, s36
    v_perm_b32 v19, v165, v161, s35
    v_mfma_f32_16x16x32_bf16 v[40:43], v[8:11], v[76:79], v[40:43]
    v_perm_b32 v23, v165, v161, s36
    v_perm_b32 v27, v166, v162, s35
    v_mfma_f32_16x16x32_bf16 v[44:47], v[12:15], v[76:79], v[44:47]
    v_perm_b32 v31, v166, v162, s36
    v_perm_b32 v35, v167, v163, s35
    v_mfma_f32_16x16x32_bf16 v[48:51], v[16:19], v[76:79], v[48:51]
    v_perm_b32 v39, v167, v163, s36
    v_mfma_f32_16x16x32_bf16 v[52:55], v[20:23], v[76:79], v[52:55]
    s_waitcnt vmcnt(30)
    buffer_load_dwordx4 v[160:163], v1, s[24:27], s32 offen offset:3584 nt
    buffer_load_dwordx4 v[164:167], v1, s[24:27], s32 offen offset:3840 nt
    v_mfma_f32_16x16x32_bf16 v[56:59], v[24:27], v[76:79], v[56:59]
    v_perm_b32 v8, v172, v168, s35
    v_perm_b32 v12, v172, v168, s36
    v_mfma_f32_16x16x32_bf16 v[60:63], v[28:31], v[76:79], v[60:63]
    v_perm_b32 v16, v173, v169, s35
    v_perm_b32 v20, v173, v169, s36
    v_mfma_f32_16x16x32_bf16 v[64:67], v[32:35], v[76:79], v[64:67]
    v_perm_b32 v24, v174, v170, s35
    v_perm_b32 v28, v174, v170, s36
    v_mfma_f32_16x16x32_bf16 v[68:71], v[36:39], v[76:79], v[68:71]
    v_perm_b32 v32, v175, v171, s35
    v_perm_b32 v36, v175, v171, s36
    s_waitcnt vmcnt(30)
    buffer_load_dwordx4 v[168:171], v2, s[24:27], s32 offen offset:0 nt
    buffer_load_dwordx4 v[172:175], v2, s[24:27], s32 offen offset:256 nt
    v_perm_b32 v9, v180, v176, s35
    v_perm_b32 v13, v180, v176, s36
    v_perm_b32 v17, v181, v177, s35
    v_perm_b32 v21, v181, v177, s36
    v_perm_b32 v25, v182, v178, s35
    v_perm_b32 v29, v182, v178, s36
    v_perm_b32 v33, v183, v179, s35
    v_perm_b32 v37, v183, v179, s36
    s_waitcnt vmcnt(30)
    buffer_load_dwordx4 v[176:179], v2, s[24:27], s32 offen offset:512 nt
    buffer_load_dwordx4 v[180:183], v2, s[24:27], s32 offen offset:768 nt
    v_perm_b32 v10, v188, v184, s35
    v_perm_b32 v14, v188, v184, s36
    v_perm_b32 v18, v189, v185, s35
    v_perm_b32 v22, v189, v185, s36
    v_perm_b32 v26, v190, v186, s35
    v_perm_b32 v30, v190, v186, s36
    v_perm_b32 v34, v191, v187, s35
    v_perm_b32 v38, v191, v187, s36
    s_waitcnt vmcnt(30)
    buffer_load_dwordx4 v[184:187], v2, s[24:27], s32 offen offset:1024 nt
    buffer_load_dwordx4 v[188:191], v2, s[24:27], s32 offen offset:1280 nt
    v_perm_b32 v11, v196, v192, s35
    v_perm_b32 v15, v196, v192, s36
    v_perm_b32 v19, v197, v193, s35
    v_mfma_f32_16x16x32_bf16 v[40:43], v[8:11], v[80:83], v[40:43]
    v_perm_b32 v23, v197, v193, s36
    v_perm_b32 v27, v198, v194, s35
    v_mfma_f32_16x16x32_bf16 v[44:47], v[12:15], v[80:83], v[44:47]
    v_perm_b32 v31, v198, v194, s36
    v_perm_b32 v35, v199, v195, s35
    v_mfma_f32_16x16x32_bf16 v[48:51], v[16:19], v[80:83], v[48:51]
    v_perm_b32 v39, v199, v195, s36
    v_mfma_f32_16x16x32_bf16 v[52:55], v[20:23], v[80:83], v[52:55]
    s_waitcnt vmcnt(30)
    buffer_load_dwordx4 v[192:195], v2, s[24:27], s32 offen offset:1536 nt
    buffer_load_dwordx4 v[196:199], v2, s[24:27], s32 offen offset:1792 nt
    v_mfma_f32_16x16x32_bf16 v[56:59], v[24:27], v[80:83], v[56:59]
    v_perm_b32 v8, v204, v200, s35
    v_perm_b32 v12, v204, v200, s36
    v_mfma_f32_16x16x32_bf16 v[60:63], v[28:31], v[80:83], v[60:63]
    v_perm_b32 v16, v205, v201, s35
    v_perm_b32 v20, v205, v201, s36
    v_mfma_f32_16x16x32_bf16 v[64:67], v[32:35], v[80:83], v[64:67]
    v_perm_b32 v24, v206, v202, s35
    v_perm_b32 v28, v206, v202, s36
    v_mfma_f32_16x16x32_bf16 v[68:71], v[36:39], v[80:83], v[68:71]
    v_perm_b32 v32, v207, v203, s35
    v_perm_b32 v36, v207, v203, s36
    s_waitcnt vmcnt(30)
    buffer_load_dwordx4 v[200:203], v2, s[24:27], s32 offen offset:2048 nt
    buffer_load_dwordx4 v[204:207], v2, s[24:27], s32 offen offset:2304 nt
    v_perm_b32 v9, v212, v208, s35
    v_perm_b32 v13, v212, v208, s36
    v_perm_b32 v17, v213, v209, s35
    v_perm_b32 v21, v213, v209, s36
    v_perm_b32 v25, v214, v210, s35
    v_perm_b32 v29, v214, v210, s36
    v_perm_b32 v33, v215, v211, s35
    v_perm_b32 v37, v215, v211, s36
    s_waitcnt vmcnt(25)
    buffer_load_dwordx4 v[208:211], v2, s[24:27], s32 offen offset:2560 nt
    buffer_load_dwordx4 v[212:215], v2, s[24:27], s32 offen offset:2816 nt
    v_perm_b32 v10, v220, v216, s35
    v_perm_b32 v14, v220, v216, s36
    v_perm_b32 v18, v221, v217, s35
    v_perm_b32 v22, v221, v217, s36
    v_perm_b32 v26, v222, v218, s35
    v_perm_b32 v30, v222, v218, s36
    v_perm_b32 v34, v223, v219, s35
    v_perm_b32 v38, v223, v219, s36
    s_waitcnt vmcnt(25)
    buffer_load_dwordx4 v[216:219], v2, s[24:27], s32 offen offset:3072 nt
    buffer_load_dwordx4 v[220:223], v2, s[24:27], s32 offen offset:3328 nt
    v_perm_b32 v11, v228, v224, s35
    v_perm_b32 v15, v228, v224, s36
    v_perm_b32 v19, v229, v225, s35
    v_mfma_f32_16x16x32_bf16 v[40:43], v[8:11], v[84:87], v[40:43]
    v_perm_b32 v23, v229, v225, s36
    v_perm_b32 v27, v230, v226, s35
    v_mfma_f32_16x16x32_bf16 v[44:47], v[12:15], v[84:87], v[44:47]
    v_perm_b32 v31, v230, v226, s36
    v_perm_b32 v35, v231, v227, s35
    v_mfma_f32_16x16x32_bf16 v[48:51], v[16:19], v[84:87], v[48:51]
    v_perm_b32 v39, v231, v227, s36
    v_mfma_f32_16x16x32_bf16 v[52:55], v[20:23], v[84:87], v[52:55]
    s_waitcnt vmcnt(25)
    buffer_load_dwordx4 v[224:227], v2, s[24:27], s32 offen offset:3584 nt
    buffer_load_dwordx4 v[228:231], v2, s[24:27], s32 offen offset:3840 nt
    s_add_u32 s34, s34, 1
    s_and_b32 s34, s34, 31
    s_and_b32 s3, s34, 3
    s_lshl_b32 s3, s3, 14
    s_lshr_b32 s32, s34, 2
    s_lshl_b32 s32, s32, 17
    s_or_b32 s32, s32, s3
    s_lshr_b32 s33, s32, 7
    s_add_u32 s39, s39, 1
    s_cmp_lg_u32 s39, 32
    s_cbranch_scc1 L_adv26
    s_add_u32 s24, s24, 2097152
    s_addc_u32 s25, s25, 0
    s_cmp_eq_u32 s51, 1
    s_cselect_b64 s[24:25], s[28:29], s[24:25]
    s_cselect_b64 s[20:21], s[12:13], s[20:21]
    s_mov_b32 s39, 0
    s_add_u32 s51, s51, 1
    s_cmp_ge_u32 s51, 4
    s_cselect_b32 s26, 0, s26
    s_cselect_b32 s22, 0, s22
L_adv26:
    s_cmp_eq_u32 s86, 0
    s_cbranch_scc1 L_np27
    s_mov_b32 s86, 0
    s_waitcnt lgkmcnt(0)
    s_barrier
L_np27:
    v_mfma_f32_16x16x32_bf16 v[56:59], v[24:27], v[84:87], v[56:59]
    v_perm_b32 v8, v108, v104, s35
    v_perm_b32 v12, v108, v104, s36
    v_mfma_f32_16x16x32_bf16 v[60:63], v[28:31], v[84:87], v[60:63]
    v_perm_b32 v16, v109, v105, s35
    v_perm_b32 v20, v109, v105, s36
    v_mfma_f32_16x16x32_bf16 v[64:67], v[32:35], v[84:87], v[64:67]
    v_perm_b32 v24, v110, v106, s35
    v_perm_b32 v28, v110, v106, s36
    v_mfma_f32_16x16x32_bf16 v[68:71], v[36:39], v[84:87], v[68:71]
    v_perm_b32 v32, v111, v107, s35
    v_perm_b32 v36, v111, v107, s36
    s_waitcnt vmcnt(25)
    buffer_load_dwordx4 v[72:75], v3, s[20:23], s33 offen offset:0
    buffer_load_dwordx4 v[76:79], v3, s[20:23], s33 offen offset:16
    buffer_load_dwordx4 v[80:83], v3, s[20:23], s33 offen offset:32
    buffer_load_dwordx4 v[84:87], v3, s[20:23], s33 offen offset:48
    buffer_load_dwordx4 v[104:107], v1, s[24:27], s32 offen offset:0 nt
    buffer_load_dwordx4 v[108:111], v1, s[24:27], s32 offen offset:256 nt
    v_perm_b32 v9, v116, v112, s35
    v_perm_b32 v13, v116, v112, s36
    v_perm_b32 v17, v117, v113, s35
    v_perm_b32 v21, v117, v113, s36
    v_perm_b32 v25, v118, v114, s35
    v_perm_b32 v29, v118, v114, s36
    v_perm_b32 v33, v119, v115, s35
    v_perm_b32 v37, v119, v115, s36
    s_waitcnt vmcnt(29)
    buffer_load_dwordx4 v[112:115], v1, s[24:27], s32 offen offset:512 nt
    buffer_load_dwordx4 v[116:119], v1, s[24:27], s32 offen offset:768 nt
    v_perm_b32 v10, v124, v120, s35
    v_perm_b32 v14, v124, v120, s36
    v_perm_b32 v18, v125, v121, s35
    v_perm_b32 v22, v125, v121, s36
    v_perm_b32 v26, v126, v122, s35
    v_perm_b32 v30, v126, v122, s36
    v_perm_b32 v34, v127, v123, s35
    v_perm_b32 v38, v127, v123, s36
    s_waitcnt vmcnt(29)
    buffer_load_dwordx4 v[120:123], v1, s[24:27], s32 offen offset:1024 nt
    buffer_load_dwordx4 v[124:127], v1, s[24:27], s32 offen offset:1280 nt
    v_perm_b32 v11, v132, v128, s35
    v_perm_b32 v15, v132, v128, s36
    v_perm_b32 v19, v133, v129, s35
    v_mfma_f32_16x16x32_bf16 v[40:43], v[8:11], v[88:91], v[40:43]
    v_perm_b32 v23, v133, v129, s36
    v_perm_b32 v27, v134, v130, s35
    v_mfma_f32_16x16x32_bf16 v[44:47], v[12:15], v[88:91], v[44:47]
    v_perm_b32 v31, v134, v130, s36
    v_perm_b32 v35, v135, v131, s35
    v_mfma_f32_16x16x32_bf16 v[48:51], v[16:19], v[88:91], v[48:51]
    v_perm_b32 v39, v135, v131, s36
    v_mfma_f32_16x16x32_bf16 v[52:55], v[20:23], v[88:91], v[52:55]
    s_waitcnt vmcnt(29)
    buffer_load_dwordx4 v[128:131], v1, s[24:27], s32 offen offset:1536 nt
    buffer_load_dwordx4 v[132:135], v1, s[24:27], s32 offen offset:1792 nt
    v_mfma_f32_16x16x32_bf16 v[56:59], v[24:27], v[88:91], v[56:59]
    v_perm_b32 v8, v140, v136, s35
    v_perm_b32 v12, v140, v136, s36
    v_mfma_f32_16x16x32_bf16 v[60:63], v[28:31], v[88:91], v[60:63]
    v_perm_b32 v16, v141, v137, s35
    v_perm_b32 v20, v141, v137, s36
    v_mfma_f32_16x16x32_bf16 v[64:67], v[32:35], v[88:91], v[64:67]
    v_perm_b32 v24, v142, v138, s35
    v_perm_b32 v28, v142, v138, s36
    v_mfma_f32_16x16x32_bf16 v[68:71], v[36:39], v[88:91], v[68:71]
    v_perm_b32 v32, v143, v139, s35
    v_perm_b32 v36, v143, v139, s36
    s_waitcnt vmcnt(29)
    buffer_load_dwordx4 v[136:139], v1, s[24:27], s32 offen offset:2048 nt
    buffer_load_dwordx4 v[140:143], v1, s[24:27], s32 offen offset:2304 nt
    v_perm_b32 v9, v148, v144, s35
    v_perm_b32 v13, v148, v144, s36
    v_perm_b32 v17, v149, v145, s35
    v_perm_b32 v21, v149, v145, s36
    v_perm_b32 v25, v150, v146, s35
    v_perm_b32 v29, v150, v146, s36
    v_perm_b32 v33, v151, v147, s35
    v_perm_b32 v37, v151, v147, s36
    s_waitcnt vmcnt(29)
    buffer_load_dwordx4 v[144:147], v1, s[24:27], s32 offen offset:2560 nt
    buffer_load_dwordx4 v[148:151], v1, s[24:27], s32 offen offset:2816 nt
    s_memrealtime s[80:81]
    s_add_u32 s87, s87, 1
    s_add_u32 s82, s82, 1721
    v_readlane_b32 s85, v232, s84
    v_perm_b32 v10, v156, v152, s35
    v_perm_b32 v14, v156, v152, s36
    v_perm_b32 v18, v157, v153, s35
    v_perm_b32 v22, v157, v153, s36
    v_perm_b32 v26, v158, v154, s35
    v_perm_b32 v30, v158, v154, s36
    v_perm_b32 v34, v159, v155, s35
    v_perm_b32 v38, v159, v155, s36
    s_waitcnt vmcnt(29)
    buffer_load_dwordx4 v[152:155], v1, s[24:27], s32 offen offset:3072 nt
    buffer_load_dwordx4 v[156:159], v1, s[24:27], s32 offen offset:3328 nt
    v_perm_b32 v11, v164, v160, s35
    v_perm_b32 v15, v164, v160, s36
    v_perm_b32 v19, v165, v161, s35
    v_mfma_f32_16x16x32_bf16 v[40:43], v[8:11], v[92:95], v[40:43]
    v_perm_b32 v23, v165, v161, s36
    v_perm_b32 v27, v166, v162, s35
    v_mfma_f32_16x16x32_bf16 v[44:47], v[12:15], v[92:95], v[44:47]
    v_perm_b32 v31, v166, v162, s36
    v_perm_b32 v35, v167, v163, s35
    v_mfma_f32_16x16x32_bf16 v[48:51], v[16:19], v[92:95], v[48:51]
    v_perm_b32 v39, v167, v163, s36
    v_mfma_f32_16x16x32_bf16 v[52:55], v[20:23], v[92:95], v[52:55]
    s_waitcnt vmcnt(29)
    buffer_load_dwordx4 v[160:163], v1, s[24:27], s32 offen offset:3584 nt
    buffer_load_dwordx4 v[164:167], v1, s[24:27], s32 offen offset:3840 nt
    v_mfma_f32_16x16x32_bf16 v[56:59], v[24:27], v[92:95], v[56:59]
    v_perm_b32 v8, v172, v168, s35
    v_perm_b32 v12, v172, v168, s36
    v_mfma_f32_16x16x32_bf16 v[60:63], v[28:31], v[92:95], v[60:63]
    v_perm_b32 v16, v173, v169, s35
    v_perm_b32 v20, v173, v169, s36
    v_mfma_f32_16x16x32_bf16 v[64:67], v[32:35], v[92:95], v[64:67]
    v_perm_b32 v24, v174, v170, s35
    v_perm_b32 v28, v174, v170, s36
    v_mfma_f32_16x16x32_bf16 v[68:71], v[36:39], v[92:95], v[68:71]
    v_perm_b32 v32, v175, v171, s35
    v_perm_b32 v36, v175, v171, s36
    s_waitcnt vmcnt(29)
    buffer_load_dwordx4 v[168:171], v2, s[24:27], s32 offen offset:0 nt
    buffer_load_dwordx4 v[172:175], v2, s[24:27], s32 offen offset:256 nt
    s_bfe_u32 s58, s85, 0x180003
    s_lshr_b32 s3, s85, 28
    s_cmp_eq_u32 s3, 8
    s_cselect_b32 s83, s58, s83
    s_cselect_b32 s98, 0, s98
    s_cselect_b32 s77, s76, s77
    s_addc_u32 s84, s84, 0
    s_bitcmp1_b64 s[94:95], s87
    s_cselect_b32 s98, 64, s98
    v_perm_b32 v9, v180, v176, s35
    v_perm_b32 v13, v180, v176, s36
    v_perm_b32 v17, v181, v177, s35
    v_perm_b32 v21, v181, v177, s36
    v_perm_b32 v25, v182, v178, s35
    v_perm_b32 v29, v182, v178, s36
    v_perm_b32 v33, v183, v179, s35
    v_perm_b32 v37, v183, v179, s36
    s_waitcnt vmcnt(29)
    buffer_load_dwordx4 v[176:179], v2, s[24:27], s32 offen offset:512 nt
    buffer_load_dwordx4 v[180:183], v2, s[24:27], s32 offen offset:768 nt
    s_lshr_b32 s3, s82, 3
    s_waitcnt lgkmcnt(0)
    s_sub_u32 s80, s80, s3
    s_sub_u32 s3, s80, s40
    s_mov_b32 s40, s80
    s_cmp_gt_i32 s3, 110
    s_cselect_b32 s3, s3, 0
    s_add_u32 s77, s77, s3
    s_add_u32 s76, s76, s3
    s_bitcmp1_b64 s[100:101], s87
    s_cselect_b32 s76, 0, s76
    s_sub_u32 s89, s80, s77
    s_sub_u32 s89, s89, s83
    s_bfe_i32 s89, s89, 0x180000
    s_bitcmp0_b64 s[90:91], s87
    s_cbranch_scc1 L_rp28
    s_and_b32 s92, s80, 0xffffff
    s_or_b32 s92, s92, 0x10000000
    s_atomic_add s92, s[78:79], s88
    s_add_u32 s88, s88, 4
L_rp28:
    v_perm_b32 v10, v188, v184, s35
    v_perm_b32 v14, v188, v184, s36
    v_perm_b32 v18, v189, v185, s35
    v_perm_b32 v22, v189, v185, s36
    v_perm_b32 v26, v190, v186, s35
    v_perm_b32 v30, v190, v186, s36
    v_perm_b32 v34, v191, v187, s35
    v_perm_b32 v38, v191, v187, s36
    s_waitcnt vmcnt(29)
    buffer_load_dwordx4 v[184:187], v2, s[24:27], s32 offen offset:1024 nt
    buffer_load_dwordx4 v[188:191], v2, s[24:27], s32 offen offset:1280 nt
    v_perm_b32 v11, v196, v192, s35
    v_perm_b32 v15, v196, v192, s36
    v_perm_b32 v19, v197, v193, s35
    v_mfma_f32_16x16x32_bf16 v[40:43], v[8:11], v[96:99], v[40:43]
    v_perm_b32 v23, v197, v193, s36
    v_perm_b32 v27, v198, v194, s35
    v_mfma_f32_16x16x32_bf16 v[44:47], v[12:15], v[96:99], v[44:47]
    v_perm_b32 v31, v198, v194, s36
    v_perm_b32 v35, v199, v195, s35
    v_mfma_f32_16x16x32_bf16 v[48:51], v[16:19], v[96:99], v[48:51]
    v_perm_b32 v39, v199, v195, s36
    v_mfma_f32_16x16x32_bf16 v[52:55], v[20:23], v[96:99], v[52:55]
    s_waitcnt vmcnt(29)
    buffer_load_dwordx4 v[192:195], v2, s[24:27], s32 offen offset:1536 nt
    buffer_load_dwordx4 v[196:199], v2, s[24:27], s32 offen offset:1792 nt
    v_mfma_f32_16x16x32_bf16 v[56:59], v[24:27], v[96:99], v[56:59]
    v_perm_b32 v8, v204, v200, s35
    v_perm_b32 v12, v204, v200, s36
    v_mfma_f32_16x16x32_bf16 v[60:63], v[28:31], v[96:99], v[60:63]
    v_perm_b32 v16, v205, v201, s35
    v_perm_b32 v20, v205, v201, s36
    v_mfma_f32_16x16x32_bf16 v[64:67], v[32:35], v[96:99], v[64:67]
    v_perm_b32 v24, v206, v202, s35
    v_perm_b32 v28, v206, v202, s36
    v_mfma_f32_16x16x32_bf16 v[68:71], v[36:39], v[96:99], v[68:71]
    v_perm_b32 v32, v207, v203, s35
    v_perm_b32 v36, v207, v203, s36
    s_waitcnt vmcnt(29)
    buffer_load_dwordx4 v[200:203], v2, s[24:27], s32 offen offset:2048 nt
    buffer_load_dwordx4 v[204:207], v2, s[24:27], s32 offen offset:2304 nt
    s_mov_b32 s93, 0
    s_cmp_ge_u32 s87, 52
    s_cselect_b32 s3, 1, 0
    s_lshl_b32 s89, s89, s3
    s_cmp_ge_i32 s89, -80
    s_addc_u32 s93, s93, 0
    s_cmp_ge_i32 s89, 80
    s_addc_u32 s93, s93, 0
    s_cmp_ge_i32 s89, 250
    s_addc_u32 s93, s93, 0
    s_cmp_eq_u32 s83, -1
    s_cselect_b32 s93, 1, s93
    s_cmp_lt_i32 s89, 80
    s_cselect_b32 s3, 5, 4
    s_cmp_ge_u32 s87, 63
    s_cselect_b32 s93, s3, s93
    v_perm_b32 v9, v212, v208, s35
    v_perm_b32 v13, v212, v208, s36
    v_perm_b32 v17, v213, v209, s35
    v_perm_b32 v21, v213, v209, s36
    v_perm_b32 v25, v214, v210, s35
    v_perm_b32 v29, v214, v210, s36
    v_perm_b32 v33, v215, v211, s35
    v_perm_b32 v37, v215, v211, s36
    s_waitcnt vmcnt(25)
    buffer_load_dwordx4 v[208:211], v2, s[24:27], s32 offen offset:2560 nt
    buffer_load_dwordx4 v[212:215], v2, s[24:27], s32 offen offset:2816 nt
    v_perm_b32 v10, v220, v216, s35
    v_perm_b32 v14, v220, v216, s36
    v_perm_b32 v18, v221, v217, s35
    v_perm_b32 v22, v221, v217, s36
    v_perm_b32 v26, v222, v218, s35
    v_perm_b32 v30, v222, v218, s36
    v_perm_b32 v34, v223, v219, s35
    v_perm_b32 v38, v223, v219, s36
    s_waitcnt vmcnt(25)
    buffer_load_dwordx4 v[216:219], v2, s[24:27], s32 offen offset:3072 nt
    buffer_load_dwordx4 v[220:223], v2, s[24:27], s32 offen offset:3328 nt
    v_perm_b32 v11, v228, v224, s35
    v_perm_b32 v15, v228, v224, s36
    v_perm_b32 v19, v229, v225, s35
    v_mfma_f32_16x16x32_bf16 v[40:43], v[8:11], v[100:103], v[40:43]
    v_perm_b32 v23, v229, v225, s36
    v_perm_b32 v27, v230, v226, s35
    v_mfma_f32_16x16x32_bf16 v[44:47], v[12:15], v[100:103], v[44:47]
    v_perm_b32 v31, v230, v226, s36
    v_perm_b32 v35, v231, v227, s35
    v_mfma_f32_16x16x32_bf16 v[48:51], v[16:19], v[100:103], v[48:51]
    v_perm_b32 v39, v231, v227, s36
    v_mfma_f32_16x16x32_bf16 v[52:55], v[20:23], v[100:103], v[52:55]
    s_waitcnt vmcnt(25)
    buffer_load_dwordx4 v[224:227], v2, s[24:27], s32 offen offset:3584 nt
    buffer_load_dwordx4 v[228:231], v2, s[24:27], s32 offen offset:3840 nt
    v_mfma_f32_16x16x32_bf16 v[56:59], v[24:27], v[100:103], v[56:59]
    v_mfma_f32_16x16x32_bf16 v[60:63], v[28:31], v[100:103], v[60:63]
    v_mfma_f32_16x16x32_bf16 v[64:67], v[32:35], v[100:103], v[64:67]
    v_mfma_f32_16x16x32_bf16 v[68:71], v[36:39], v[100:103], v[68:71]
    s_sub_u32 s38, s38, 1
    s_cbranch_scc1 L_k_done
    s_cmp_eq_u32 s93, 3
    s_cbranch_scc1 L_k3
    s_branch L_k_top
L_k_top:
    s_cmp_eq_u32 s93, 0
    s_cbranch_scc1 L_k0
    s_cmp_eq_u32 s93, 1
    s_cbranch_scc1 L_k1
    s_cmp_eq_u32 s93, 2
    s_cbranch_scc1 L_k2
    s_branch L_k3
L_k_done:
    s_lshl_b32 s3, s41, 13
    v_add_u32 v4, s3, v6
    s_add_u32 s41, s41, 1
    s_mov_b32 s86, 1
    s_mov_b32 s38, 15
    s_cmp_lt_u32 s41, 2
    s_cbranch_scc1 L_k_top
L_v_top:
    s_cmp_eq_u32 s93, 0
    s_cbranch_scc1 L_v0
    s_cmp_eq_u32 s93, 1
    s_cbranch_scc1 L_v1
    s_cmp_eq_u32 s93, 2
    s_cbranch_scc1 L_v2
    s_cmp_eq_u32 s93, 3
    s_cbranch_scc1 L_v3
    s_cmp_eq_u32 s93, 5
    s_cbranch_scc1 L_v5
    s_branch L_v4
    .p2align 3
L_v1:
    s_add_u32 s34, s34, 1
    s_and_b32 s34, s34, 31
    s_and_b32 s3, s34, 3
    s_lshl_b32 s3, s3, 14
    s_lshr_b32 s32, s34, 2
    s_lshl_b32 s32, s32, 17
    s_or_b32 s32, s32, s3
    s_lshr_b32 s33, s32, 7
    s_add_u32 s39, s39, 1
    s_cmp_lg_u32 s39, 32
    s_cbranch_scc1 L_adv29
    s_add_u32 s24, s24, 2097152
    s_addc_u32 s25, s25, 0
    s_cmp_eq_u32 s51, 1
    s_cselect_b64 s[24:25], s[28:29], s[24:25]
    s_cselect_b64 s[20:21], s[12:13], s[20:21]
    s_mov_b32 s39, 0
    s_add_u32 s51, s51, 1
    s_cmp_ge_u32 s51, 4
    s_cselect_b32 s26, 0, s26
    s_cselect_b32 s22, 0, s22
L_adv29:
    s_waitcnt vmcnt(30)
    v_perm_b32 v8, v108, v104, s35
    v_perm_b32 v12, v108, v104, s36
    v_perm_b32 v16, v109, v105, s35
    v_perm_b32 v20, v109, v105, s36
    v_perm_b32 v24, v110, v106, s35
    v_perm_b32 v28, v110, v106, s36
    v_perm_b32 v32, v111, v107, s35
    v_perm_b32 v36, v111, v107, s36
    s_waitcnt vmcnt(19)
    buffer_load_dwordx4 v[88:91], v3, s[20:23], s33 offen offset:0
    buffer_load_dwordx4 v[92:95], v3, s[20:23], s33 offen offset:16
    buffer_load_dwordx4 v[96:99], v3, s[20:23], s33 offen offset:32
    buffer_load_dwordx4 v[100:103], v3, s[20:23], s33 offen offset:48
    buffer_load_dword v232, v233, s[96:99], 0 offen sc1
    buffer_load_dwordx4 v[104:107], v1, s[24:27], s32 offen offset:0 nt
    buffer_load_dwordx4 v[108:111], v1, s[24:27], s32 offen offset:256 nt
    s_cmp_lg_u32 s86, 1
    s_cbranch_scc1 L_nd30
    ds_write_b128 v4, v[40:43] offset:0
    ds_write_b128 v4, v[44:47] offset:1024
    ds_write_b128 v4, v[48:51] offset:2048
    ds_write_b128 v4, v[52:55] offset:3072
L_nd30:
    v_perm_b32 v9, v116, v112, s35
    v_perm_b32 v13, v116, v112, s36
    v_perm_b32 v17, v117, v113, s35
    v_perm_b32 v21, v117, v113, s36
    v_perm_b32 v25, v118, v114, s35
    v_perm_b32 v29, v118, v114, s36
    v_perm_b32 v33, v119, v115, s35
    v_perm_b32 v37, v119, v115, s36
    s_waitcnt vmcnt(24)
    buffer_load_dwordx4 v[112:115], v1, s[24:27], s32 offen offset:512 nt
    buffer_load_dwordx4 v[116:119], v1, s[24:27], s32 offen offset:768 nt
    s_cmp_lg_u32 s86, 1
    s_cbranch_scc1 L_nd31
    ds_write_b128 v4, v[56:59] offset:4096
    ds_write_b128 v4, v[60:63] offset:5120
    ds_write_b128 v4, v[64:67] offset:6144
    ds_write_b128 v4, v[68:71] offset:7168
    v_mov_b64 v[40:41], 0
    v_mov_b64 v[42:43], 0
    v_mov_b64 v[44:45], 0
    v_mov_b64 v[46:47], 0
    v_mov_b64 v[48:49], 0
    v_mov_b64 v[50:51], 0
    v_mov_b64 v[52:53], 0
    v_mov_b64 v[54:55], 0
L_nd31:
    v_perm_b32 v10, v124, v120, s35
    v_perm_b32 v14, v124, v120, s36
    v_perm_b32 v18, v125, v121, s35
    v_perm_b32 v22, v125, v121, s36
    v_perm_b32 v26, v126, v122, s35
    v_perm_b32 v30, v126, v122, s36
    v_perm_b32 v34, v127, v123, s35
    v_perm_b32 v38, v127, v123, s36
    s_waitcnt vmcnt(24)
    buffer_load_dwordx4 v[120:123], v1, s[24:27], s32 offen offset:1024 nt
    buffer_load_dwordx4 v[124:127], v1, s[24:27], s32 offen offset:1280 nt
    s_cmp_lg_u32 s86, 1
    s_cbranch_scc1 L_nd32
    v_mov_b64 v[56:57], 0
    v_mov_b64 v[58:59], 0
    v_mov_b64 v[60:61], 0
    v_mov_b64 v[62:63], 0
    v_mov_b64 v[64:65], 0
    v_mov_b64 v[66:67], 0
    v_mov_b64 v[68:69], 0
    v_mov_b64 v[70:71], 0
L_nd32:
    v_perm_b32 v11, v132, v128, s35
    v_perm_b32 v15, v132, v128, s36
    v_perm_b32 v19, v133, v129, s35
    v_mfma_f32_16x16x32_bf16 v[40:43], v[72:75], v[8:11], v[40:43]
    v_perm_b32 v23, v133, v129, s36
    v_perm_b32 v27, v134, v130, s35
    v_mfma_f32_16x16x32_bf16 v[44:47], v[72:75], v[12:15], v[44:47]
    v_perm_b32 v31, v134, v130, s36
    v_perm_b32 v35, v135, v131, s35
    v_mfma_f32_16x16x32_bf16 v[48:51], v[72:75], v[16:19], v[48:51]
    v_perm_b32 v39, v135, v131, s36
    v_mfma_f32_16x16x32_bf16 v[52:55], v[72:75], v[20:23], v[52:55]
    s_waitcnt vmcnt(24)
    buffer_load_dwordx4 v[128:131], v1, s[24:27], s32 offen offset:1536 nt
    buffer_load_dwordx4 v[132:135], v1, s[24:27], s32 offen offset:1792 nt
    v_mfma_f32_16x16x32_bf16 v[56:59], v[72:75], v[24:27], v[56:59]
    v_perm_b32 v8, v140, v136, s35
    v_perm_b32 v12, v140, v136, s36
    v_mfma_f32_16x16x32_bf16 v[60:63], v[72:75], v[28:31], v[60:63]
    v_perm_b32 v16, v141, v137, s35
    v_perm_b32 v20, v141, v137, s36
    v_mfma_f32_16x16x32_bf16 v[64:67], v[72:75], v[32:35], v[64:67]
    v_perm_b32 v24, v142, v138, s35
    v_perm_b32 v28, v142, v138, s36
    v_mfma_f32_16x16x32_bf16 v[68:71], v[72:75], v[36:39], v[68:71]
    v_perm_b32 v32, v143, v139, s35
    v_perm_b32 v36, v143, v139, s36
    s_waitcnt vmcnt(24)
    buffer_load_dwordx4 v[136:139], v1, s[24:27], s32 offen offset:2048 nt
    buffer_load_dwordx4 v[140:143], v1, s[24:27], s32 offen offset:2304 nt
    v_perm_b32 v9, v148, v144, s35
    v_perm_b32 v13, v148, v144, s36
    v_perm_b32 v17, v149, v145, s35
    v_perm_b32 v21, v149, v145, s36
    v_perm_b32 v25, v150, v146, s35
    v_perm_b32 v29, v150, v146, s36
    v_perm_b32 v33, v151, v147, s35
    v_perm_b32 v37, v151, v147, s36
    s_waitcnt vmcnt(24)
    buffer_load_dwordx4 v[144:147], v1, s[24:27], s32 offen offset:2560 nt
    buffer_load_dwordx4 v[148:151], v1, s[24:27], s32 offen offset:2816 nt
    v_perm_b32 v10, v156, v152, s35
    v_perm_b32 v14, v156, v152, s36
    v_perm_b32 v18, v157, v153, s35
    v_perm_b32 v22, v157, v153, s36
    v_perm_b32 v26, v158, v154, s35
    v_perm_b32 v30, v158, v154, s36
    v_perm_b32 v34, v159, v155, s35
    v_perm_b32 v38, v159, v155, s36
    s_waitcnt vmcnt(24)
    buffer_load_dwordx4 v[152:155], v1, s[24:27], s32 offen offset:3072 nt
    buffer_load_dwordx4 v[156:159], v1, s[24:27], s32 offen offset:3328 nt
    v_perm_b32 v11, v164, v160, s35
    v_perm_b32 v15, v164, v160, s36
    v_perm_b32 v19, v165, v161, s35
    v_mfma_f32_16x16x32_bf16 v[40:43], v[76:79], v[8:11], v[40:43]
    v_perm_b32 v23, v165, v161, s36
    v_perm_b32 v27, v166, v162, s35
    v_mfma_f32_16x16x32_bf16 v[44:47], v[76:79], v[12:15], v[44:47]
    v_perm_b32 v31, v166, v162, s36
    v_perm_b32 v35, v167, v163, s35
    v_mfma_f32_16x16x32_bf16 v[48:51], v[76:79], v[16:19], v[48:51]
    v_perm_b32 v39, v167, v163, s36
    v_mfma_f32_16x16x32_bf16 v[52:55], v[76:79], v[20:23], v[52:55]
    s_waitcnt vmcnt(24)
    buffer_load_dwordx4 v[160:163], v1, s[24:27], s32 offen offset:3584 nt
    buffer_load_dwordx4 v[164:167], v1, s[24:27], s32 offen offset:3840 nt
    v_mfma_f32_16x16x32_bf16 v[56:59], v[76:79], v[24:27], v[56:59]
    v_perm_b32 v8, v172, v168, s35
    v_perm_b32 v12, v172, v168, s36
    v_mfma_f32_16x16x32_bf16 v[60:63], v[76:79], v[28:31], v[60:63]
    v_perm_b32 v16, v173, v169, s35
    v_perm_b32 v20, v173, v169, s36
    v_mfma_f32_16x16x32_bf16 v[64:67], v[76:79], v[32:35], v[64:67]
    v_perm_b32 v24, v174, v170, s35
    v_perm_b32 v28, v174, v170, s36
    v_mfma_f32_16x16x32_bf16 v[68:71], v[76:79], v[36:39], v[68:71]
    v_perm_b32 v32, v175, v171, s35
    v_perm_b32 v36, v175, v171, s36
    s_waitcnt vmcnt(24)
    buffer_load_dwordx4 v[168:171], v2, s[24:27], s32 offen offset:0 nt
    buffer_load_dwordx4 v[172:175], v2, s[24:27], s32 offen offset:256 nt
    v_perm_b32 v9, v180, v176, s35
    v_perm_b32 v13, v180, v176, s36
    v_perm_b32 v17, v181, v177, s35
    v_perm_b32 v21, v181, v177, s36
    v_perm_b32 v25, v182, v178, s35
    v_perm_b32 v29, v182, v178, s36
    v_perm_b32 v33, v183, v179, s35
    v_perm_b32 v37, v183, v179, s36
    s_waitcnt vmcnt(24)
    buffer_load_dwordx4 v[176:179], v2, s[24:27], s32 offen offset:512 nt
    buffer_load_dwordx4 v[180:183], v2, s[24:27], s32 offen offset:768 nt
    v_perm_b32 v10, v188, v184, s35
    v_perm_b32 v14, v188, v184, s36
    v_perm_b32 v18, v189, v185, s35
    v_perm_b32 v22, v189, v185, s36
    v_perm_b32 v26, v190, v186, s35
    v_perm_b32 v30, v190, v186, s36
    v_perm_b32 v34, v191, v187, s35
    v_perm_b32 v38, v191, v187, s36
    s_waitcnt vmcnt(19)
    buffer_load_dwordx4 v[184:187], v2, s[24:27], s32 offen offset:1024 nt
    buffer_load_dwordx4 v[188:191], v2, s[24:27], s32 offen offset:1280 nt
    v_perm_b32 v11, v196, v192, s35
    v_perm_b32 v15, v196, v192, s36
    v_perm_b32 v19, v197, v193, s35
    v_mfma_f32_16x16x32_bf16 v[40:43], v[80:83], v[8:11], v[40:43]
    v_perm_b32 v23, v197, v193, s36
    v_perm_b32 v27, v198, v194, s35
    v_mfma_f32_16x16x32_bf16 v[44:47], v[80:83], v[12:15], v[44:47]
    v_perm_b32 v31, v198, v194, s36
    v_perm_b32 v35, v199, v195, s35
    v_mfma_f32_16x16x32_bf16 v[48:51], v[80:83], v[16:19], v[48:51]
    v_perm_b32 v39, v199, v195, s36
    v_mfma_f32_16x16x32_bf16 v[52:55], v[80:83], v[20:23], v[52:55]
    s_waitcnt vmcnt(19)
    buffer_load_dwordx4 v[192:195], v2, s[24:27], s32 offen offset:1536 nt
    buffer_load_dwordx4 v[196:199], v2, s[24:27], s32 offen offset:1792 nt
    v_mfma_f32_16x16x32_bf16 v[56:59], v[80:83], v[24:27], v[56:59]
    v_perm_b32 v8, v204, v200, s35
    v_perm_b32 v12, v204, v200, s36
    v_mfma_f32_16x16x32_bf16 v[60:63], v[80:83], v[28:31], v[60:63]
    v_perm_b32 v16, v205, v201, s35
    v_perm_b32 v20, v205, v201, s36
    v_mfma_f32_16x16x32_bf16 v[64:67], v[80:83], v[32:35], v[64:67]
    v_perm_b32 v24, v206, v202, s35
    v_perm_b32 v28, v206, v202, s36
    v_mfma_f32_16x16x32_bf16 v[68:71], v[80:83], v[36:39], v[68:71]
    v_perm_b32 v32, v207, v203, s35
    v_perm_b32 v36, v207, v203, s36
    s_waitcnt vmcnt(19)
    buffer_load_dwordx4 v[200:203], v2, s[24:27], s32 offen offset:2048 nt
    buffer_load_dwordx4 v[204:207], v2, s[24:27], s32 offen offset:2304 nt
    v_perm_b32 v9, v212, v208, s35
    v_perm_b32 v13, v212, v208, s36
    v_perm_b32 v17, v213, v209, s35
    v_perm_b32 v21, v213, v209, s36
    v_perm_b32 v25, v214, v210, s35
    v_perm_b32 v29, v214, v210, s36
    v_perm_b32 v33, v215, v211, s35
    v_perm_b32 v37, v215, v211, s36
    s_waitcnt vmcnt(19)
    buffer_load_dwordx4 v[208:211], v2, s[24:27], s32 offen offset:2560 nt
    buffer_load_dwordx4 v[212:215], v2, s[24:27], s32 offen offset:2816 nt
    v_perm_b32 v10, v220, v216, s35
    v_perm_b32 v14, v220, v216, s36
    v_perm_b32 v18, v221, v217, s35
    v_perm_b32 v22, v221, v217, s36
    v_perm_b32 v26, v222, v218, s35
    v_perm_b32 v30, v222, v218, s36
    v_perm_b32 v34, v223, v219, s35
    v_perm_b32 v38, v223, v219, s36
    s_waitcnt vmcnt(19)
    buffer_load_dwordx4 v[216:219], v2, s[24:27], s32 offen offset:3072 nt
    buffer_load_dwordx4 v[220:223], v2, s[24:27], s32 offen offset:3328 nt
    v_perm_b32 v11, v228, v224, s35
    v_perm_b32 v15, v228, v224, s36
    v_perm_b32 v19, v229, v225, s35
    v_mfma_f32_16x16x32_bf16 v[40:43], v[84:87], v[8:11], v[40:43]
    v_perm_b32 v23, v229, v225, s36
    v_perm_b32 v27, v230, v226, s35
    v_mfma_f32_16x16x32_bf16 v[44:47], v[84:87], v[12:15], v[44:47]
    v_perm_b32 v31, v230, v226, s36
    v_perm_b32 v35, v231, v227, s35
    v_mfma_f32_16x16x32_bf16 v[48:51], v[84:87], v[16:19], v[48:51]
    v_perm_b32 v39, v231, v227, s36
    v_mfma_f32_16x16x32_bf16 v[52:55], v[84:87], v[20:23], v[52:55]
    s_waitcnt vmcnt(19)
    buffer_load_dwordx4 v[224:227], v2, s[24:27], s32 offen offset:3584 nt
    buffer_load_dwordx4 v[228:231], v2, s[24:27], s32 offen offset:3840 nt
    s_add_u32 s34, s34, 1
    s_and_b32 s34, s34, 31
    s_and_b32 s3, s34, 3
    s_lshl_b32 s3, s3, 14
    s_lshr_b32 s32, s34, 2
    s_lshl_b32 s32, s32, 17
    s_or_b32 s32, s32, s3
    s_lshr_b32 s33, s32, 7
    s_add_u32 s39, s39, 1
    s_cmp_lg_u32 s39, 32
    s_cbranch_scc1 L_adv33
    s_add_u32 s24, s24, 2097152
    s_addc_u32 s25, s25, 0
    s_cmp_eq_u32 s51, 1
    s_cselect_b64 s[24:25], s[28:29], s[24:25]
    s_cselect_b64 s[20:21], s[12:13], s[20:21]
    s_mov_b32 s39, 0
    s_add_u32 s51, s51, 1
    s_cmp_ge_u32 s51, 4
    s_cselect_b32 s26, 0, s26
    s_cselect_b32 s22, 0, s22
L_adv33:
    s_cmp_eq_u32 s86, 0
    s_cbranch_scc1 L_np34
    s_mov_b32 s86, 0
    s_waitcnt lgkmcnt(0)
    s_barrier
L_np34:
    v_mfma_f32_16x16x32_bf16 v[56:59], v[84:87], v[24:27], v[56:59]
    v_perm_b32 v8, v108, v104, s35
    v_perm_b32 v12, v108, v104, s36
    v_mfma_f32_16x16x32_bf16 v[60:63], v[84:87], v[28:31], v[60:63]
    v_perm_b32 v16, v109, v105, s35
    v_perm_b32 v20, v109, v105, s36
    v_mfma_f32_16x16x32_bf16 v[64:67], v[84:87], v[32:35], v[64:67]
    v_perm_b32 v24, v110, v106, s35
    v_perm_b32 v28, v110, v106, s36
    v_mfma_f32_16x16x32_bf16 v[68:71], v[84:87], v[36:39], v[68:71]
    v_perm_b32 v32, v111, v107, s35
    v_perm_b32 v36, v111, v107, s36
    s_waitcnt vmcnt(19)
    buffer_load_dwordx4 v[72:75], v3, s[20:23], s33 offen offset:0
    buffer_load_dwordx4 v[76:79], v3, s[20:23], s33 offen offset:16
    buffer_load_dwordx4 v[80:83], v3, s[20:23], s33 offen offset:32
    buffer_load_dwordx4 v[84:87], v3, s[20:23], s33 offen offset:48
    buffer_load_dwordx4 v[104:107], v1, s[24:27], s32 offen offset:0 nt
    buffer_load_dwordx4 v[108:111], v1, s[24:27], s32 offen offset:256 nt
    v_perm_b32 v9, v116, v112, s35
    v_perm_b32 v13, v116, v112, s36
    v_perm_b32 v17, v117, v113, s35
    v_perm_b32 v21, v117, v113, s36
    v_perm_b32 v25, v118, v114, s35
    v_perm_b32 v29, v118, v114, s36
    v_perm_b32 v33, v119, v115, s35
    v_perm_b32 v37, v119, v115, s36
    s_waitcnt vmcnt(23)
    buffer_load_dwordx4 v[112:115], v1, s[24:27], s32 offen offset:512 nt
    buffer_load_dwordx4 v[116:119], v1, s[24:27], s32 offen offset:768 nt
    v_perm_b32 v10, v124, v120, s35
    v_perm_b32 v14, v124, v120, s36
    v_perm_b32 v18, v125, v121, s35
    v_perm_b32 v22, v125, v121, s36
    v_perm_b32 v26, v126, v122, s35
    v_perm_b32 v30, v126, v122, s36
    v_perm_b32 v34, v127, v123, s35
    v_perm_b32 v38, v127, v123, s36
    s_waitcnt vmcnt(23)
    buffer_load_dwordx4 v[120:123], v1, s[24:27], s32 offen offset:1024 nt
    buffer_load_dwordx4 v[124:127], v1, s[24:27], s32 offen offset:1280 nt
    v_perm_b32 v11, v132, v128, s35
    v_perm_b32 v15, v132, v128, s36
    v_perm_b32 v19, v133, v129, s35
    v_mfma_f32_16x16x32_bf16 v[40:43], v[88:91], v[8:11], v[40:43]
    v_perm_b32 v23, v133, v129, s36
    v_perm_b32 v27, v134, v130, s35
    v_mfma_f32_16x16x32_bf16 v[44:47], v[88:91], v[12:15], v[44:47]
    v_perm_b32 v31, v134, v130, s36
    v_perm_b32 v35, v135, v131, s35
    v_mfma_f32_16x16x32_bf16 v[48:51], v[88:91], v[16:19], v[48:51]
    v_perm_b32 v39, v135, v131, s36
    v_mfma_f32_16x16x32_bf16 v[52:55], v[88:91], v[20:23], v[52:55]
    s_waitcnt vmcnt(23)
    buffer_load_dwordx4 v[128:131], v1, s[24:27], s32 offen offset:1536 nt
    buffer_load_dwordx4 v[132:135], v1, s[24:27], s32 offen offset:1792 nt
    v_mfma_f32_16x16x32_bf16 v[56:59], v[88:91], v[24:27], v[56:59]
    v_perm_b32 v8, v140, v136, s35
    v_perm_b32 v12, v140, v136, s36
    v_mfma_f32_16x16x32_bf16 v[60:63], v[88:91], v[28:31], v[60:63]
    v_perm_b32 v16, v141, v137, s35
    v_perm_b32 v20, v141, v137, s36
    v_mfma_f32_16x16x32_bf16 v[64:67], v[88:91], v[32:35], v[64:67]
    v_perm_b32 v24, v142, v138, s35
    v_perm_b32 v28, v142, v138, s36
    v_mfma_f32_16x16x32_bf16 v[68:71], v[88:91], v[36:39], v[68:71]
    v_perm_b32 v32, v143, v139, s35
    v_perm_b32 v36, v143, v139, s36
    s_waitcnt vmcnt(23)
    buffer_load_dwordx4 v[136:139], v1, s[24:27], s32 offen offset:2048 nt
    buffer_load_dwordx4 v[140:143], v1, s[24:27], s32 offen offset:2304 nt
    v_perm_b32 v9, v148, v144, s35
    v_perm_b32 v13, v148, v144, s36
    v_perm_b32 v17, v149, v145, s35
    v_perm_b32 v21, v149, v145, s36
    v_perm_b32 v25, v150, v146, s35
    v_perm_b32 v29, v150, v146, s36
    v_perm_b32 v33, v151, v147, s35
    v_perm_b32 v37, v151, v147, s36
    s_waitcnt vmcnt(23)
    buffer_load_dwordx4 v[144:147], v1, s[24:27], s32 offen offset:2560 nt
    buffer_load_dwordx4 v[148:151], v1, s[24:27], s32 offen offset:2816 nt
    s_memrealtime s[80:81]
    s_add_u32 s87, s87, 1
    s_add_u32 s82, s82, 1721
    v_readlane_b32 s85, v232, s84
    v_perm_b32 v10, v156, v152, s35
    v_perm_b32 v14, v156, v152, s36
    v_perm_b32 v18, v157, v153, s35
    v_perm_b32 v22, v157, v153, s36
    v_perm_b32 v26, v158, v154, s35
    v_perm_b32 v30, v158, v154, s36
    v_perm_b32 v34, v159, v155, s35
    v_perm_b32 v38, v159, v155, s36
    s_waitcnt vmcnt(23)
    buffer_load_dwordx4 v[152:155], v1, s[24:27], s32 offen offset:3072 nt
    buffer_load_dwordx4 v[156:159], v1, s[24:27], s32 offen offset:3328 nt
    v_perm_b32 v11, v164, v160, s35
    v_perm_b32 v15, v164, v160, s36
    v_perm_b32 v19, v165, v161, s35
    v_mfma_f32_16x16x32_bf16 v[40:43], v[92:95], v[8:11], v[40:43]
    v_perm_b32 v23, v165, v161, s36
    v_perm_b32 v27, v166, v162, s35
    v_mfma_f32_16x16x32_bf16 v[44:47], v[92:95], v[12:15], v[44:47]
    v_perm_b32 v31, v166, v162, s36
    v_perm_b32 v35, v167, v163, s35
    v_mfma_f32_16x16x32_bf16 v[48:51], v[92:95], v[16:19], v[48:51]
    v_perm_b32 v39, v167, v163, s36
    v_mfma_f32_16x16x32_bf16 v[52:55], v[92:95], v[20:23], v[52:55]
    s_waitcnt vmcnt(23)
    buffer_load_dwordx4 v[160:163], v1, s[24:27], s32 offen offset:3584 nt
    buffer_load_dwordx4 v[164:167], v1, s[24:27], s32 offen offset:3840 nt
    v_mfma_f32_16x16x32_bf16 v[56:59], v[92:95], v[24:27], v[56:59]
    v_perm_b32 v8, v172, v168, s35
    v_perm_b32 v12, v172, v168, s36
    v_mfma_f32_16x16x32_bf16 v[60:63], v[92:95], v[28:31], v[60:63]
    v_perm_b32 v16, v173, v169, s35
    v_perm_b32 v20, v173, v169, s36
    v_mfma_f32_16x16x32_bf16 v[64:67], v[92:95], v[32:35], v[64:67]
    v_perm_b32 v24, v174, v170, s35
    v_perm_b32 v28, v174, v170, s36
    v_mfma_f32_16x16x32_bf16 v[68:71], v[92:95], v[36:39], v[68:71]
    v_perm_b32 v32, v175, v171, s35
    v_perm_b32 v36, v175, v171, s36
    s_waitcnt vmcnt(23)
    buffer_load_dwordx4 v[168:171], v2, s[24:27], s32 offen offset:0 nt
    buffer_load_dwordx4 v[172:175], v2, s[24:27], s32 offen offset:256 nt
    s_bfe_u32 s58, s85, 0x180003
    s_lshr_b32 s3, s85, 28
    s_cmp_eq_u32 s3, 8
    s_cselect_b32 s83, s58, s83
    s_cselect_b32 s98, 0, s98
    s_cselect_b32 s77, s76, s77
    s_addc_u32 s84, s84, 0
    s_bitcmp1_b64 s[94:95], s87
    s_cselect_b32 s98, 64, s98
    v_perm_b32 v9, v180, v176, s35
    v_perm_b32 v13, v180, v176, s36
    v_perm_b32 v17, v181, v177, s35
    v_perm_b32 v21, v181, v177, s36
    v_perm_b32 v25, v182, v178, s35
    v_perm_b32 v29, v182, v178, s36
    v_perm_b32 v33, v183, v179, s35
    v_perm_b32 v37, v183, v179, s36
    s_waitcnt vmcnt(23)
    buffer_load_dwordx4 v[176:179], v2, s[24:27], s32 offen offset:512 nt
    buffer_load_dwordx4 v[180:183], v2, s[24:27], s32 offen offset:768 nt
    s_lshr_b32 s3, s82, 3
    s_waitcnt lgkmcnt(0)
    s_sub_u32 s80, s80, s3
    s_sub_u32 s3, s80, s40
    s_mov_b32 s40, s80
    s_cmp_gt_i32 s3, 110
    s_cselect_b32 s3, s3, 0
    s_add_u32 s77, s77, s3
    s_add_u32 s76, s76, s3
    s_bitcmp1_b64 s[100:101], s87
    s_cselect_b32 s76, 0, s76
    s_sub_u32 s89, s80, s77
    s_sub_u32 s89, s89, s83
    s_bfe_i32 s89, s89, 0x180000
    s_bitcmp0_b64 s[90:91], s87
    s_cbranch_scc1 L_rp35
    s_and_b32 s92, s80, 0xffffff
    s_or_b32 s92, s92, 0x10000000
    s_atomic_add s92, s[78:79], s88
    s_add_u32 s88, s88, 4
L_rp35:
    v_perm_b32 v10, v188, v184, s35
    v_perm_b32 v14, v188, v184, s36
    v_perm_b32 v18, v189, v185, s35
    v_perm_b32 v22, v189, v185, s36
    v_perm_b32 v26, v190, v186, s35
    v_perm_b32 v30, v190, v186, s36
    v_perm_b32 v34, v191, v187, s35
    v_perm_b32 v38, v191, v187, s36
    s_waitcnt vmcnt(19)
    buffer_load_dwordx4 v[184:187], v2, s[24:27], s32 offen offset:1024 nt
    buffer_load_dwordx4 v[188:191], v2, s[24:27], s32 offen offset:1280 nt
    v_perm_b32 v11, v196, v192, s35
    v_perm_b32 v15, v196, v192, s36
    v_perm_b32 v19, v197, v193, s35
    v_mfma_f32_16x16x32_bf16 v[40:43], v[96:99], v[8:11], v[40:43]
    v_perm_b32 v23, v197, v193, s36
    v_perm_b32 v27, v198, v194, s35
    v_mfma_f32_16x16x32_bf16 v[44:47], v[96:99], v[12:15], v[44:47]
    v_perm_b32 v31, v198, v194, s36
    v_perm_b32 v35, v199, v195, s35
    v_mfma_f32_16x16x32_bf16 v[48:51], v[96:99], v[16:19], v[48:51]
    v_perm_b32 v39, v199, v195, s36
    v_mfma_f32_16x16x32_bf16 v[52:55], v[96:99], v[20:23], v[52:55]
    s_waitcnt vmcnt(19)
    buffer_load_dwordx4 v[192:195], v2, s[24:27], s32 offen offset:1536 nt
    buffer_load_dwordx4 v[196:199], v2, s[24:27], s32 offen offset:1792 nt
    v_mfma_f32_16x16x32_bf16 v[56:59], v[96:99], v[24:27], v[56:59]
    v_perm_b32 v8, v204, v200, s35
    v_perm_b32 v12, v204, v200, s36
    v_mfma_f32_16x16x32_bf16 v[60:63], v[96:99], v[28:31], v[60:63]
    v_perm_b32 v16, v205, v201, s35
    v_perm_b32 v20, v205, v201, s36
    v_mfma_f32_16x16x32_bf16 v[64:67], v[96:99], v[32:35], v[64:67]
    v_perm_b32 v24, v206, v202, s35
    v_perm_b32 v28, v206, v202, s36
    v_mfma_f32_16x16x32_bf16 v[68:71], v[96:99], v[36:39], v[68:71]
    v_perm_b32 v32, v207, v203, s35
    v_perm_b32 v36, v207, v203, s36
    s_waitcnt vmcnt(19)
    buffer_load_dwordx4 v[200:203], v2, s[24:27], s32 offen offset:2048 nt
    buffer_load_dwordx4 v[204:207], v2, s[24:27], s32 offen offset:2304 nt
    s_mov_b32 s93, 0
    s_cmp_ge_u32 s87, 52
    s_cselect_b32 s3, 1, 0
    s_lshl_b32 s89, s89, s3
    s_cmp_ge_i32 s89, -80
    s_addc_u32 s93, s93, 0
    s_cmp_ge_i32 s89, 80
    s_addc_u32 s93, s93, 0
    s_cmp_ge_i32 s89, 250
    s_addc_u32 s93, s93, 0
    s_cmp_eq_u32 s83, -1
    s_cselect_b32 s93, 1, s93
    s_cmp_lt_i32 s89, 80
    s_cselect_b32 s3, 5, 4
    s_cmp_ge_u32 s87, 63
    s_cselect_b32 s93, s3, s93
    v_perm_b32 v9, v212, v208, s35
    v_perm_b32 v13, v212, v208, s36
    v_perm_b32 v17, v213, v209, s35
    v_perm_b32 v21, v213, v209, s36
    v_perm_b32 v25, v214, v210, s35
    v_perm_b32 v29, v214, v210, s36
    v_perm_b32 v33, v215, v211, s35
    v_perm_b32 v37, v215, v211, s36
    s_waitcnt vmcnt(19)
    buffer_load_dwordx4 v[208:211], v2, s[24:27], s32 offen offset:2560 nt
    buffer_load_dwordx4 v[212:215], v2, s[24:27], s32 offen offset:2816 nt
    v_perm_b32 v10, v220, v216, s35
    v_perm_b32 v14, v220, v216, s36
    v_perm_b32 v18, v221, v217, s35
    v_perm_b32 v22, v221, v217, s36
    v_perm_b32 v26, v222, v218, s35
    v_perm_b32 v30, v222, v218, s36
    v_perm_b32 v34, v223, v219, s35
    v_perm_b32 v38, v223, v219, s36
    s_waitcnt vmcnt(19)
    buffer_load_dwordx4 v[216:219], v2, s[24:27], s32 offen offset:3072 nt
    buffer_load_dwordx4 v[220:223], v2, s[24:27], s32 offen offset:3328 nt
    v_perm_b32 v11, v228, v224, s35
    v_perm_b32 v15, v228, v224, s36
    v_perm_b32 v19, v229, v225, s35
    v_mfma_f32_16x16x32_bf16 v[40:43], v[100:103], v[8:11], v[40:43]
    v_perm_b32 v23, v229, v225, s36
    v_perm_b32 v27, v230, v226, s35
    v_mfma_f32_16x16x32_bf16 v[44:47], v[100:103], v[12:15], v[44:47]
    v_perm_b32 v31, v230, v226, s36
    v_perm_b32 v35, v231, v227, s35
    v_mfma_f32_16x16x32_bf16 v[48:51], v[100:103], v[16:19], v[48:51]
    v_perm_b32 v39, v231, v227, s36
    v_mfma_f32_16x16x32_bf16 v[52:55], v[100:103], v[20:23], v[52:55]
    s_waitcnt vmcnt(19)
    buffer_load_dwordx4 v[224:227], v2, s[24:27], s32 offen offset:3584 nt
    buffer_load_dwordx4 v[228:231], v2, s[24:27], s32 offen offset:3840 nt
    v_mfma_f32_16x16x32_bf16 v[56:59], v[100:103], v[24:27], v[56:59]
    v_mfma_f32_16x16x32_bf16 v[60:63], v[100:103], v[28:31], v[60:63]
    v_mfma_f32_16x16x32_bf16 v[64:67], v[100:103], v[32:35], v[64:67]
    v_mfma_f32_16x16x32_bf16 v[68:71], v[100:103], v[36:39], v[68:71]
    s_sub_u32 s38, s38, 1
    s_cbranch_scc1 L_v_done
    s_cmp_eq_u32 s93, 1
    s_cbranch_scc1 L_v1
    s_branch L_v_top
    .p2align 3
L_v0:
    s_add_u32 s34, s34, 1
    s_and_b32 s34, s34, 31
    s_and_b32 s3, s34, 3
    s_lshl_b32 s3, s3, 14
    s_lshr_b32 s32, s34, 2
    s_lshl_b32 s32, s32, 17
    s_or_b32 s32, s32, s3
    s_lshr_b32 s33, s32, 7
    s_add_u32 s39, s39, 1
    s_cmp_lg_u32 s39, 32
    s_cbranch_scc1 L_adv36
    s_add_u32 s24, s24, 2097152
    s_addc_u32 s25, s25, 0
    s_cmp_eq_u32 s51, 1
    s_cselect_b64 s[24:25], s[28:29], s[24:25]
    s_cselect_b64 s[20:21], s[12:13], s[20:21]
    s_mov_b32 s39, 0
    s_add_u32 s51, s51, 1
    s_cmp_ge_u32 s51, 4
    s_cselect_b32 s26, 0, s26
    s_cselect_b32 s22, 0, s22
L_adv36:
    s_waitcnt vmcnt(30)
    v_perm_b32 v8, v108, v104, s35
    v_perm_b32 v12, v108, v104, s36
    v_perm_b32 v16, v109, v105, s35
    v_perm_b32 v20, v109, v105, s36
    v_perm_b32 v24, v110, v106, s35
    v_perm_b32 v28, v110, v106, s36
    v_perm_b32 v32, v111, v107, s35
    v_perm_b32 v36, v111, v107, s36
    s_waitcnt vmcnt(17)
    buffer_load_dwordx4 v[88:91], v3, s[20:23], s33 offen offset:0
    buffer_load_dwordx4 v[92:95], v3, s[20:23], s33 offen offset:16
    buffer_load_dwordx4 v[96:99], v3, s[20:23], s33 offen offset:32
    buffer_load_dwordx4 v[100:103], v3, s[20:23], s33 offen offset:48
    buffer_load_dword v232, v233, s[96:99], 0 offen sc1
    buffer_load_dwordx4 v[104:107], v1, s[24:27], s32 offen offset:0 nt
    buffer_load_dwordx4 v[108:111], v1, s[24:27], s32 offen offset:256 nt
    s_cmp_lg_u32 s86, 1
    s_cbranch_scc1 L_nd37
    ds_write_b128 v4, v[40:43] offset:0
    ds_write_b128 v4, v[44:47] offset:1024
    ds_write_b128 v4, v[48:51] offset:2048
    ds_write_b128 v4, v[52:55] offset:3072
L_nd37:
    v_perm_b32 v9, v116, v112, s35
    v_perm_b32 v13, v116, v112, s36
    v_perm_b32 v17, v117, v113, s35
    v_perm_b32 v21, v117, v113, s36
    v_perm_b32 v25, v118, v114, s35
    v_perm_b32 v29, v118, v114, s36
    v_perm_b32 v33, v119, v115, s35
    v_perm_b32 v37, v119, v115, s36
    s_waitcnt vmcnt(22)
    buffer_load_dwordx4 v[112:115], v1, s[24:27], s32 offen offset:512 nt
    buffer_load_dwordx4 v[116:119], v1, s[24:27], s32 offen offset:768 nt
    s_cmp_lg_u32 s86, 1
    s_cbranch_scc1 L_nd38
    ds_write_b128 v4, v[56:59] offset:4096
    ds_write_b128 v4, v[60:63] offset:5120
    ds_write_b128 v4, v[64:67] offset:6144
    ds_write_b128 v4, v[68:71] offset:7168
    v_mov_b64 v[40:41], 0
    v_mov_b64 v[42:43], 0
    v_mov_b64 v[44:45], 0
    v_mov_b64 v[46:47], 0
    v_mov_b64 v[48:49], 0
    v_mov_b64 v[50:51], 0
    v_mov_b64 v[52:53], 0
    v_mov_b64 v[54:55], 0
L_nd38:
    v_perm_b32 v10, v124, v120, s35
    v_perm_b32 v14, v124, v120, s36
    v_perm_b32 v18, v125, v121, s35
    v_perm_b32 v22, v125, v121, s36
    v_perm_b32 v26, v126, v122, s35
    v_perm_b32 v30, v126, v122, s36
    v_perm_b32 v34, v127, v123, s35
    v_perm_b32 v38, v127, v123, s36
    s_waitcnt vmcnt(22)
    buffer_load_dwordx4 v[120:123], v1, s[24:27], s32 offen offset:1024 nt
    buffer_load_dwordx4 v[124:127], v1, s[24:27], s32 offen offset:1280 nt
    s_cmp_lg_u32 s86, 1
    s_cbranch_scc1 L_nd39
    v_mov_b64 v[56:57], 0
    v_mov_b64 v[58:59], 0
    v_mov_b64 v[60:61], 0
    v_mov_b64 v[62:63], 0
    v_mov_b64 v[64:65], 0
    v_mov_b64 v[66:67], 0
    v_mov_b64 v[68:69], 0
    v_mov_b64 v[70:71], 0
L_nd39:
    v_perm_b32 v11, v132, v128, s35
    v_perm_b32 v15, v132, v128, s36
    v_perm_b32 v19, v133, v129, s35
    v_mfma_f32_16x16x32_bf16 v[40:43], v[72:75], v[8:11], v[40:43]
    v_perm_b32 v23, v133, v129, s36
    v_perm_b32 v27, v134, v130, s35
    v_mfma_f32_16x16x32_bf16 v[44:47], v[72:75], v[12:15], v[44:47]
    v_perm_b32 v31, v134, v130, s36
    v_perm_b32 v35, v135, v131, s35
    v_mfma_f32_16x16x32_bf16 v[48:51], v[72:75], v[16:19], v[48:51]
    v_perm_b32 v39, v135, v131, s36
    v_mfma_f32_16x16x32_bf16 v[52:55], v[72:75], v[20:23], v[52:55]
    s_waitcnt vmcnt(22)
    buffer_load_dwordx4 v[128:131], v1, s[24:27], s32 offen offset:1536 nt
    buffer_load_dwordx4 v[132:135], v1, s[24:27], s32 offen offset:1792 nt
    v_mfma_f32_16x16x32_bf16 v[56:59], v[72:75], v[24:27], v[56:59]
    v_perm_b32 v8, v140, v136, s35
    v_perm_b32 v12, v140, v136, s36
    v_mfma_f32_16x16x32_bf16 v[60:63], v[72:75], v[28:31], v[60:63]
    v_perm_b32 v16, v141, v137, s35
    v_perm_b32 v20, v141, v137, s36
    v_mfma_f32_16x16x32_bf16 v[64:67], v[72:75], v[32:35], v[64:67]
    v_perm_b32 v24, v142, v138, s35
    v_perm_b32 v28, v142, v138, s36
    v_mfma_f32_16x16x32_bf16 v[68:71], v[72:75], v[36:39], v[68:71]
    v_perm_b32 v32, v143, v139, s35
    v_perm_b32 v36, v143, v139, s36
    s_waitcnt vmcnt(22)
    buffer_load_dwordx4 v[136:139], v1, s[24:27], s32 offen offset:2048 nt
    buffer_load_dwordx4 v[140:143], v1, s[24:27], s32 offen offset:2304 nt
    v_perm_b32 v9, v148, v144, s35
    v_perm_b32 v13, v148, v144, s36
    v_perm_b32 v17, v149, v145, s35
    v_perm_b32 v21, v149, v145, s36
    v_perm_b32 v25, v150, v146, s35
    v_perm_b32 v29, v150, v146, s36
    v_perm_b32 v33, v151, v147, s35
    v_perm_b32 v37, v151, v147, s36
    s_waitcnt vmcnt(22)
    buffer_load_dwordx4 v[144:147], v1, s[24:27], s32 offen offset:2560 nt
    buffer_load_dwordx4 v[148:151], v1, s[24:27], s32 offen offset:2816 nt
    v_perm_b32 v10, v156, v152, s35
    v_perm_b32 v14, v156, v152, s36
    v_perm_b32 v18, v157, v153, s35
    v_perm_b32 v22, v157, v153, s36
    v_perm_b32 v26, v158, v154, s35
    v_perm_b32 v30, v158, v154, s36
    v_perm_b32 v34, v159, v155, s35
    v_perm_b32 v38, v159, v155, s36
    s_waitcnt vmcnt(22)
    buffer_load_dwordx4 v[152:155], v1, s[24:27], s32 offen offset:3072 nt
    buffer_load_dwordx4 v[156:159], v1, s[24:27], s32 offen offset:3328 nt
    v_perm_b32 v11, v164, v160, s35
    v_perm_b32 v15, v164, v160, s36
    v_perm_b32 v19, v165, v161, s35
    v_mfma_f32_16x16x32_bf16 v[40:43], v[76:79], v[8:11], v[40:43]
    v_perm_b32 v23, v165, v161, s36
    v_perm_b32 v27, v166, v162, s35
    v_mfma_f32_16x16x32_bf16 v[44:47], v[76:79], v[12:15], v[44:47]
    v_perm_b32 v31, v166, v162, s36
    v_perm_b32 v35, v167, v163, s35
    v_mfma_f32_16x16x32_bf16 v[48:51], v[76:79], v[16:19], v[48:51]
    v_perm_b32 v39, v167, v163, s36
    v_mfma_f32_16x16x32_bf16 v[52:55], v[76:79], v[20:23], v[52:55]
    s_waitcnt vmcnt(22)
    buffer_load_dwordx4 v[160:163], v1, s[24:27], s32 offen offset:3584 nt
    buffer_load_dwordx4 v[164:167], v1, s[24:27], s32 offen offset:3840 nt
    v_mfma_f32_16x16x32_bf16 v[56:59], v[76:79], v[24:27], v[56:59]
    v_perm_b32 v8, v172, v168, s35
    v_perm_b32 v12, v172, v168, s36
    v_mfma_f32_16x16x32_bf16 v[60:63], v[76:79], v[28:31], v[60:63]
    v_perm_b32 v16, v173, v169, s35
    v_perm_b32 v20, v173, v169, s36
    v_mfma_f32_16x16x32_bf16 v[64:67], v[76:79], v[32:35], v[64:67]
    v_perm_b32 v24, v174, v170, s35
    v_perm_b32 v28, v174, v170, s36
    v_mfma_f32_16x16x32_bf16 v[68:71], v[76:79], v[36:39], v[68:71]
    v_perm_b32 v32, v175, v171, s35
    v_perm_b32 v36, v175, v171, s36
    s_waitcnt vmcnt(22)
    buffer_load_dwordx4 v[168:171], v2, s[24:27], s32 offen offset:0 nt
    buffer_load_dwordx4 v[172:175], v2, s[24:27], s32 offen offset:256 nt
    v_perm_b32 v9, v180, v176, s35
    v_perm_b32 v13, v180, v176, s36
    v_perm_b32 v17, v181, v177, s35
    v_perm_b32 v21, v181, v177, s36
    v_perm_b32 v25, v182, v178, s35
    v_perm_b32 v29, v182, v178, s36
    v_perm_b32 v33, v183, v179, s35
    v_perm_b32 v37, v183, v179, s36
    s_waitcnt vmcnt(17)
    buffer_load_dwordx4 v[176:179], v2, s[24:27], s32 offen offset:512 nt
    buffer_load_dwordx4 v[180:183], v2, s[24:27], s32 offen offset:768 nt
    v_perm_b32 v10, v188, v184, s35
    v_perm_b32 v14, v188, v184, s36
    v_perm_b32 v18, v189, v185, s35
    v_perm_b32 v22, v189, v185, s36
    v_perm_b32 v26, v190, v186, s35
    v_perm_b32 v30, v190, v186, s36
    v_perm_b32 v34, v191, v187, s35
    v_perm_b32 v38, v191, v187, s36
    s_waitcnt vmcnt(17)
    buffer_load_dwordx4 v[184:187], v2, s[24:27], s32 offen offset:1024 nt
    buffer_load_dwordx4 v[188:191], v2, s[24:27], s32 offen offset:1280 nt
    v_perm_b32 v11, v196, v192, s35
    v_perm_b32 v15, v196, v192, s36
    v_perm_b32 v19, v197, v193, s35
    v_mfma_f32_16x16x32_bf16 v[40:43], v[80:83], v[8:11], v[40:43]
    v_perm_b32 v23, v197, v193, s36
    v_perm_b32 v27, v198, v194, s35
    v_mfma_f32_16x16x32_bf16 v[44:47], v[80:83], v[12:15], v[44:47]
    v_perm_b32 v31, v198, v194, s36
    v_perm_b32 v35, v199, v195, s35
    v_mfma_f32_16x16x32_bf16 v[48:51], v[80:83], v[16:19], v[48:51]
    v_perm_b32 v39, v199, v195, s36
    v_mfma_f32_16x16x32_bf16 v[52:55], v[80:83], v[20:23], v[52:55]
    s_waitcnt vmcnt(17)
    buffer_load_dwordx4 v[192:195], v2, s[24:27], s32 offen offset:1536 nt
    buffer_load_dwordx4 v[196:199], v2, s[24:27], s32 offen offset:1792 nt
    v_mfma_f32_16x16x32_bf16 v[56:59], v[80:83], v[24:27], v[56:59]
    v_perm_b32 v8, v204, v200, s35
    v_perm_b32 v12, v204, v200, s36
    v_mfma_f32_16x16x32_bf16 v[60:63], v[80:83], v[28:31], v[60:63]
    v_perm_b32 v16, v205, v201, s35
    v_perm_b32 v20, v205, v201, s36
    v_mfma_f32_16x16x32_bf16 v[64:67], v[80:83], v[32:35], v[64:67]
    v_perm_b32 v24, v206, v202, s35
    v_perm_b32 v28, v206, v202, s36
    v_mfma_f32_16x16x32_bf16 v[68:71], v[80:83], v[36:39], v[68:71]
    v_perm_b32 v32, v207, v203, s35
    v_perm_b32 v36, v207, v203, s36
    s_waitcnt vmcnt(17)
    buffer_load_dwordx4 v[200:203], v2, s[24:27], s32 offen offset:2048 nt
    buffer_load_dwordx4 v[204:207], v2, s[24:27], s32 offen offset:2304 nt
    v_perm_b32 v9, v212, v208, s35
    v_perm_b32 v13, v212, v208, s36
    v_perm_b32 v17, v213, v209, s35
    v_perm_b32 v21, v213, v209, s36
    v_perm_b32 v25, v214, v210, s35
    v_perm_b32 v29, v214, v210, s36
    v_perm_b32 v33, v215, v211, s35
    v_perm_b32 v37, v215, v211, s36
    s_waitcnt vmcnt(17)
    buffer_load_dwordx4 v[208:211], v2, s[24:27], s32 offen offset:2560 nt
    buffer_load_dwordx4 v[212:215], v2, s[24:27], s32 offen offset:2816 nt
    v_perm_b32 v10, v220, v216, s35
    v_perm_b32 v14, v220, v216, s36
    v_perm_b32 v18, v221, v217, s35
    v_perm_b32 v22, v221, v217, s36
    v_perm_b32 v26, v222, v218, s35
    v_perm_b32 v30, v222, v218, s36
    v_perm_b32 v34, v223, v219, s35
    v_perm_b32 v38, v223, v219, s36
    s_waitcnt vmcnt(17)
    buffer_load_dwordx4 v[216:219], v2, s[24:27], s32 offen offset:3072 nt
    buffer_load_dwordx4 v[220:223], v2, s[24:27], s32 offen offset:3328 nt
    v_perm_b32 v11, v228, v224, s35
    v_perm_b32 v15, v228, v224, s36
    v_perm_b32 v19, v229, v225, s35
    v_mfma_f32_16x16x32_bf16 v[40:43], v[84:87], v[8:11], v[40:43]
    v_perm_b32 v23, v229, v225, s36
    v_perm_b32 v27, v230, v226, s35
    v_mfma_f32_16x16x32_bf16 v[44:47], v[84:87], v[12:15], v[44:47]
    v_perm_b32 v31, v230, v226, s36
    v_perm_b32 v35, v231, v227, s35
    v_mfma_f32_16x16x32_bf16 v[48:51], v[84:87], v[16:19], v[48:51]
    v_perm_b32 v39, v231, v227, s36
    v_mfma_f32_16x16x32_bf16 v[52:55], v[84:87], v[20:23], v[52:55]
    s_waitcnt vmcnt(17)
    buffer_load_dwordx4 v[224:227], v2, s[24:27], s32 offen offset:3584 nt
    buffer_load_dwordx4 v[228:231], v2, s[24:27], s32 offen offset:3840 nt
    s_add_u32 s34, s34, 1
    s_and_b32 s34, s34, 31
    s_and_b32 s3, s34, 3
    s_lshl_b32 s3, s3, 14
    s_lshr_b32 s32, s34, 2
    s_lshl_b32 s32, s32, 17
    s_or_b32 s32, s32, s3
    s_lshr_b32 s33, s32, 7
    s_add_u32 s39, s39, 1
    s_cmp_lg_u32 s39, 32
    s_cbranch_scc1 L_adv40
    s_add_u32 s24, s24, 2097152
    s_addc_u32 s25, s25, 0
    s_cmp_eq_u32 s51, 1
    s_cselect_b64 s[24:25], s[28:29], s[24:25]
    s_cselect_b64 s[20:21], s[12:13], s[20:21]
    s_mov_b32 s39, 0
    s_add_u32 s51, s51, 1
    s_cmp_ge_u32 s51, 4
    s_cselect_b32 s26, 0, s26
    s_cselect_b32 s22, 0, s22
L_adv40:
    s_cmp_eq_u32 s86, 0
    s_cbranch_scc1 L_np41
    s_mov_b32 s86, 0
    s_waitcnt lgkmcnt(0)
    s_barrier
L_np41:
    v_mfma_f32_16x16x32_bf16 v[56:59], v[84:87], v[24:27], v[56:59]
    v_perm_b32 v8, v108, v104, s35
    v_perm_b32 v12, v108, v104, s36
    v_mfma_f32_16x16x32_bf16 v[60:63], v[84:87], v[28:31], v[60:63]
    v_perm_b32 v16, v109, v105, s35
    v_perm_b32 v20, v109, v105, s36
    v_mfma_f32_16x16x32_bf16 v[64:67], v[84:87], v[32:35], v[64:67]
    v_perm_b32 v24, v110, v106, s35
    v_perm_b32 v28, v110, v106, s36
    v_mfma_f32_16x16x32_bf16 v[68:71], v[84:87], v[36:39], v[68:71]
    v_perm_b32 v32, v111, v107, s35
    v_perm_b32 v36, v111, v107, s36
    s_waitcnt vmcnt(17)
    buffer_load_dwordx4 v[72:75], v3, s[20:23], s33 offen offset:0
    buffer_load_dwordx4 v[76:79], v3, s[20:23], s33 offen offset:16
    buffer_load_dwordx4 v[80:83], v3, s[20:23], s33 offen offset:32
    buffer_load_dwordx4 v[84:87], v3, s[20:23], s33 offen offset:48
    buffer_load_dwordx4 v[104:107], v1, s[24:27], s32 offen offset:0 nt
    buffer_load_dwordx4 v[108:111], v1, s[24:27], s32 offen offset:256 nt
    v_perm_b32 v9, v116, v112, s35
    v_perm_b32 v13, v116, v112, s36
    v_perm_b32 v17, v117, v113, s35
    v_perm_b32 v21, v117, v113, s36
    v_perm_b32 v25, v118, v114, s35
    v_perm_b32 v29, v118, v114, s36
    v_perm_b32 v33, v119, v115, s35
    v_perm_b32 v37, v119, v115, s36
    s_waitcnt vmcnt(21)
    buffer_load_dwordx4 v[112:115], v1, s[24:27], s32 offen offset:512 nt
    buffer_load_dwordx4 v[116:119], v1, s[24:27], s32 offen offset:768 nt
    v_perm_b32 v10, v124, v120, s35
    v_perm_b32 v14, v124, v120, s36
    v_perm_b32 v18, v125, v121, s35
    v_perm_b32 v22, v125, v121, s36
    v_perm_b32 v26, v126, v122, s35
    v_perm_b32 v30, v126, v122, s36
    v_perm_b32 v34, v127, v123, s35
    v_perm_b32 v38, v127, v123, s36
    s_waitcnt vmcnt(21)
    buffer_load_dwordx4 v[120:123], v1, s[24:27], s32 offen offset:1024 nt
    buffer_load_dwordx4 v[124:127], v1, s[24:27], s32 offen offset:1280 nt
    v_perm_b32 v11, v132, v128, s35
    v_perm_b32 v15, v132, v128, s36
    v_perm_b32 v19, v133, v129, s35
    v_mfma_f32_16x16x32_bf16 v[40:43], v[88:91], v[8:11], v[40:43]
    v_perm_b32 v23, v133, v129, s36
    v_perm_b32 v27, v134, v130, s35
    v_mfma_f32_16x16x32_bf16 v[44:47], v[88:91], v[12:15], v[44:47]
    v_perm_b32 v31, v134, v130, s36
    v_perm_b32 v35, v135, v131, s35
    v_mfma_f32_16x16x32_bf16 v[48:51], v[88:91], v[16:19], v[48:51]
    v_perm_b32 v39, v135, v131, s36
    v_mfma_f32_16x16x32_bf16 v[52:55], v[88:91], v[20:23], v[52:55]
    s_waitcnt vmcnt(21)
    buffer_load_dwordx4 v[128:131], v1, s[24:27], s32 offen offset:1536 nt
    buffer_load_dwordx4 v[132:135], v1, s[24:27], s32 offen offset:1792 nt
    v_mfma_f32_16x16x32_bf16 v[56:59], v[88:91], v[24:27], v[56:59]
    v_perm_b32 v8, v140, v136, s35
    v_perm_b32 v12, v140, v136, s36
    v_mfma_f32_16x16x32_bf16 v[60:63], v[88:91], v[28:31], v[60:63]
    v_perm_b32 v16, v141, v137, s35
    v_perm_b32 v20, v141, v137, s36
    v_mfma_f32_16x16x32_bf16 v[64:67], v[88:91], v[32:35], v[64:67]
    v_perm_b32 v24, v142, v138, s35
    v_perm_b32 v28, v142, v138, s36
    v_mfma_f32_16x16x32_bf16 v[68:71], v[88:91], v[36:39], v[68:71]
    v_perm_b32 v32, v143, v139, s35
    v_perm_b32 v36, v143, v139, s36
    s_waitcnt vmcnt(21)
    buffer_load_dwordx4 v[136:139], v1, s[24:27], s32 offen offset:2048 nt
    buffer_load_dwordx4 v[140:143], v1, s[24:27], s32 offen offset:2304 nt
    v_perm_b32 v9, v148, v144, s35
    v_perm_b32 v13, v148, v144, s36
    v_perm_b32 v17, v149, v145, s35
    v_perm_b32 v21, v149, v145, s36
    v_perm_b32 v25, v150, v146, s35
    v_perm_b32 v29, v150, v146, s36
    v_perm_b32 v33, v151, v147, s35
    v_perm_b32 v37, v151, v147, s36
    s_waitcnt vmcnt(21)
    buffer_load_dwordx4 v[144:147], v1, s[24:27], s32 offen offset:2560 nt
    buffer_load_dwordx4 v[148:151], v1, s[24:27], s32 offen offset:2816 nt
    s_memrealtime s[80:81]
    s_add_u32 s87, s87, 1
    s_add_u32 s82, s82, 1721
    v_readlane_b32 s85, v232, s84
    v_perm_b32 v10, v156, v152, s35
    v_perm_b32 v14, v156, v152, s36
    v_perm_b32 v18, v157, v153, s35
    v_perm_b32 v22, v157, v153, s36
    v_perm_b32 v26, v158, v154, s35
    v_perm_b32 v30, v158, v154, s36
    v_perm_b32 v34, v159, v155, s35
    v_perm_b32 v38, v159, v155, s36
    s_waitcnt vmcnt(21)
    buffer_load_dwordx4 v[152:155], v1, s[24:27], s32 offen offset:3072 nt
    buffer_load_dwordx4 v[156:159], v1, s[24:27], s32 offen offset:3328 nt
    v_perm_b32 v11, v164, v160, s35
    v_perm_b32 v15, v164, v160, s36
    v_perm_b32 v19, v165, v161, s35
    v_mfma_f32_16x16x32_bf16 v[40:43], v[92:95], v[8:11], v[40:43]
    v_perm_b32 v23, v165, v161, s36
    v_perm_b32 v27, v166, v162, s35
    v_mfma_f32_16x16x32_bf16 v[44:47], v[92:95], v[12:15], v[44:47]
    v_perm_b32 v31, v166, v162, s36
    v_perm_b32 v35, v167, v163, s35
    v_mfma_f32_16x16x32_bf16 v[48:51], v[92:95], v[16:19], v[48:51]
    v_perm_b32 v39, v167, v163, s36
    v_mfma_f32_16x16x32_bf16 v[52:55], v[92:95], v[20:23], v[52:55]
    s_waitcnt vmcnt(21)
    buffer_load_dwordx4 v[160:163], v1, s[24:27], s32 offen offset:3584 nt
    buffer_load_dwordx4 v[164:167], v1, s[24:27], s32 offen offset:3840 nt
    v_mfma_f32_16x16x32_bf16 v[56:59], v[92:95], v[24:27], v[56:59]
    v_perm_b32 v8, v172, v168, s35
    v_perm_b32 v12, v172, v168, s36
    v_mfma_f32_16x16x32_bf16 v[60:63], v[92:95], v[28:31], v[60:63]
    v_perm_b32 v16, v173, v169, s35
    v_perm_b32 v20, v173, v169, s36
    v_mfma_f32_16x16x32_bf16 v[64:67], v[92:95], v[32:35], v[64:67]
    v_perm_b32 v24, v174, v170, s35
    v_perm_b32 v28, v174, v170, s36
    v_mfma_f32_16x16x32_bf16 v[68:71], v[92:95], v[36:39], v[68:71]
    v_perm_b32 v32, v175, v171, s35
    v_perm_b32 v36, v175, v171, s36
    s_waitcnt vmcnt(21)
    buffer_load_dwordx4 v[168:171], v2, s[24:27], s32 offen offset:0 nt
    buffer_load_dwordx4 v[172:175], v2, s[24:27], s32 offen offset:256 nt
    s_bfe_u32 s58, s85, 0x180003
    s_lshr_b32 s3, s85, 28
    s_cmp_eq_u32 s3, 8
    s_cselect_b32 s83, s58, s83
    s_cselect_b32 s98, 0, s98
    s_cselect_b32 s77, s76, s77
    s_addc_u32 s84, s84, 0
    s_bitcmp1_b64 s[94:95], s87
    s_cselect_b32 s98, 64, s98
    v_perm_b32 v9, v180, v176, s35
    v_perm_b32 v13, v180, v176, s36
    v_perm_b32 v17, v181, v177, s35
    v_perm_b32 v21, v181, v177, s36
    v_perm_b32 v25, v182, v178, s35
    v_perm_b32 v29, v182, v178, s36
    v_perm_b32 v33, v183, v179, s35
    v_perm_b32 v37, v183, v179, s36
    s_waitcnt vmcnt(17)
    buffer_load_dwordx4 v[176:179], v2, s[24:27], s32 offen offset:512 nt
    buffer_load_dwordx4 v[180:183], v2, s[24:27], s32 offen offset:768 nt
    s_lshr_b32 s3, s82, 3
    s_waitcnt lgkmcnt(0)
    s_sub_u32 s80, s80, s3
    s_sub_u32 s3, s80, s40
    s_mov_b32 s40, s80
    s_cmp_gt_i32 s3, 110
    s_cselect_b32 s3, s3, 0
    s_add_u32 s77, s77, s3
    s_add_u32 s76, s76, s3
    s_bitcmp1_b64 s[100:101], s87
    s_cselect_b32 s76, 0, s76
    s_sub_u32 s89, s80, s77
    s_sub_u32 s89, s89, s83
    s_bfe_i32 s89, s89, 0x180000
    s_bitcmp0_b64 s[90:91], s87
    s_cbranch_scc1 L_rp42
    s_and_b32 s92, s80, 0xffffff
    s_or_b32 s92, s92, 0x10000000
    s_atomic_add s92, s[78:79], s88
    s_add_u32 s88, s88, 4
L_rp42:
    v_perm_b32 v10, v188, v184, s35
    v_perm_b32 v14, v188, v184, s36
    v_perm_b32 v18, v189, v185, s35
    v_perm_b32 v22, v189, v185, s36
    v_perm_b32 v26, v190, v186, s35
    v_perm_b32 v30, v190, v186, s36
    v_perm_b32 v34, v191, v187, s35
    v_perm_b32 v38, v191, v187, s36
    s_waitcnt vmcnt(17)
    buffer_load_dwordx4 v[184:187], v2, s[24:27], s32 offen offset:1024 nt
    buffer_load_dwordx4 v[188:191], v2, s[24:27], s32 offen offset:1280 nt
    v_perm_b32 v11, v196, v192, s35
    v_perm_b32 v15, v196, v192, s36
    v_perm_b32 v19, v197, v193, s35
    v_mfma_f32_16x16x32_bf16 v[40:43], v[96:99], v[8:11], v[40:43]
    v_perm_b32 v23, v197, v193, s36
    v_perm_b32 v27, v198, v194, s35
    v_mfma_f32_16x16x32_bf16 v[44:47], v[96:99], v[12:15], v[44:47]
    v_perm_b32 v31, v198, v194, s36
    v_perm_b32 v35, v199, v195, s35
    v_mfma_f32_16x16x32_bf16 v[48:51], v[96:99], v[16:19], v[48:51]
    v_perm_b32 v39, v199, v195, s36
    v_mfma_f32_16x16x32_bf16 v[52:55], v[96:99], v[20:23], v[52:55]
    s_waitcnt vmcnt(17)
    buffer_load_dwordx4 v[192:195], v2, s[24:27], s32 offen offset:1536 nt
    buffer_load_dwordx4 v[196:199], v2, s[24:27], s32 offen offset:1792 nt
    v_mfma_f32_16x16x32_bf16 v[56:59], v[96:99], v[24:27], v[56:59]
    v_perm_b32 v8, v204, v200, s35
    v_perm_b32 v12, v204, v200, s36
    v_mfma_f32_16x16x32_bf16 v[60:63], v[96:99], v[28:31], v[60:63]
    v_perm_b32 v16, v205, v201, s35
    v_perm_b32 v20, v205, v201, s36
    v_mfma_f32_16x16x32_bf16 v[64:67], v[96:99], v[32:35], v[64:67]
    v_perm_b32 v24, v206, v202, s35
    v_perm_b32 v28, v206, v202, s36
    v_mfma_f32_16x16x32_bf16 v[68:71], v[96:99], v[36:39], v[68:71]
    v_perm_b32 v32, v207, v203, s35
    v_perm_b32 v36, v207, v203, s36
    s_waitcnt vmcnt(17)
    buffer_load_dwordx4 v[200:203], v2, s[24:27], s32 offen offset:2048 nt
    buffer_load_dwordx4 v[204:207], v2, s[24:27], s32 offen offset:2304 nt
    s_mov_b32 s93, 0
    s_cmp_ge_u32 s87, 52
    s_cselect_b32 s3, 1, 0
    s_lshl_b32 s89, s89, s3
    s_cmp_ge_i32 s89, -80
    s_addc_u32 s93, s93, 0
    s_cmp_ge_i32 s89, 80
    s_addc_u32 s93, s93, 0
    s_cmp_ge_i32 s89, 250
    s_addc_u32 s93, s93, 0
    s_cmp_eq_u32 s83, -1
    s_cselect_b32 s93, 1, s93
    s_cmp_lt_i32 s89, 80
    s_cselect_b32 s3, 5, 4
    s_cmp_ge_u32 s87, 63
    s_cselect_b32 s93, s3, s93
    v_perm_b32 v9, v212, v208, s35
    v_perm_b32 v13, v212, v208, s36
    v_perm_b32 v17, v213, v209, s35
    v_perm_b32 v21, v213, v209, s36
    v_perm_b32 v25, v214, v210, s35
    v_perm_b32 v29, v214, v210, s36
    v_perm_b32 v33, v215, v211, s35
    v_perm_b32 v37, v215, v211, s36
    s_waitcnt vmcnt(17)
    buffer_load_dwordx4 v[208:211], v2, s[24:27], s32 offen offset:2560 nt
    buffer_load_dwordx4 v[212:215], v2, s[24:27], s32 offen offset:2816 nt
    v_perm_b32 v10, v220, v216, s35
    v_perm_b32 v14, v220, v216, s36
    v_perm_b32 v18, v221, v217, s35
    v_perm_b32 v22, v221, v217, s36
    v_perm_b32 v26, v222, v218, s35
    v_perm_b32 v30, v222, v218, s36
    v_perm_b32 v34, v223, v219, s35
    v_perm_b32 v38, v223, v219, s36
    s_waitcnt vmcnt(17)
    buffer_load_dwordx4 v[216:219], v2, s[24:27], s32 offen offset:3072 nt
    buffer_load_dwordx4 v[220:223], v2, s[24:27], s32 offen offset:3328 nt
    v_perm_b32 v11, v228, v224, s35
    v_perm_b32 v15, v228, v224, s36
    v_perm_b32 v19, v229, v225, s35
    v_mfma_f32_16x16x32_bf16 v[40:43], v[100:103], v[8:11], v[40:43]
    v_perm_b32 v23, v229, v225, s36
    v_perm_b32 v27, v230, v226, s35
    v_mfma_f32_16x16x32_bf16 v[44:47], v[100:103], v[12:15], v[44:47]
    v_perm_b32 v31, v230, v226, s36
    v_perm_b32 v35, v231, v227, s35
    v_mfma_f32_16x16x32_bf16 v[48:51], v[100:103], v[16:19], v[48:51]
    v_perm_b32 v39, v231, v227, s36
    v_mfma_f32_16x16x32_bf16 v[52:55], v[100:103], v[20:23], v[52:55]
    s_waitcnt vmcnt(17)
    buffer_load_dwordx4 v[224:227], v2, s[24:27], s32 offen offset:3584 nt
    buffer_load_dwordx4 v[228:231], v2, s[24:27], s32 offen offset:3840 nt
    v_mfma_f32_16x16x32_bf16 v[56:59], v[100:103], v[24:27], v[56:59]
    v_mfma_f32_16x16x32_bf16 v[60:63], v[100:103], v[28:31], v[60:63]
    v_mfma_f32_16x16x32_bf16 v[64:67], v[100:103], v[32:35], v[64:67]
    v_mfma_f32_16x16x32_bf16 v[68:71], v[100:103], v[36:39], v[68:71]
    s_sub_u32 s38, s38, 1
    s_cbranch_scc1 L_v_done
    s_cmp_eq_u32 s93, 0
    s_cbranch_scc1 L_v0
    s_branch L_v_top
    .p2align 3
L_v2:
    s_add_u32 s34, s34, 1
    s_and_b32 s34, s34, 31
    s_and_b32 s3, s34, 3
    s_lshl_b32 s3, s3, 14
    s_lshr_b32 s32, s34, 2
    s_lshl_b32 s32, s32, 17
    s_or_b32 s32, s32, s3
    s_lshr_b32 s33, s32, 7
    s_add_u32 s39, s39, 1
    s_cmp_lg_u32 s39, 32
    s_cbranch_scc1 L_adv43
    s_add_u32 s24, s24, 2097152
    s_addc_u32 s25, s25, 0
    s_cmp_eq_u32 s51, 1
    s_cselect_b64 s[24:25], s[28:29], s[24:25]
    s_cselect_b64 s[20:21], s[12:13], s[20:21]
    s_mov_b32 s39, 0
    s_add_u32 s51, s51, 1
    s_cmp_ge_u32 s51, 4
    s_cselect_b32 s26, 0, s26
    s_cselect_b32 s22, 0, s22
L_adv43:
    s_waitcnt vmcnt(30)
    v_perm_b32 v8, v108, v104, s35
    v_perm_b32 v12, v108, v104, s36
    v_perm_b32 v16, v109, v105, s35
    v_perm_b32 v20, v109, v105, s36
    v_perm_b32 v24, v110, v106, s35
    v_perm_b32 v28, v110, v106, s36
    v_perm_b32 v32, v111, v107, s35
    v_perm_b32 v36, v111, v107, s36
    s_waitcnt vmcnt(21)
    buffer_load_dwordx4 v[88:91], v3, s[20:23], s33 offen offset:0
    buffer_load_dwordx4 v[92:95], v3, s[20:23], s33 offen offset:16
    buffer_load_dwordx4 v[96:99], v3, s[20:23], s33 offen offset:32
    buffer_load_dwordx4 v[100:103], v3, s[20:23], s33 offen offset:48
    buffer_load_dword v232, v233, s[96:99], 0 offen sc1
    buffer_load_dwordx4 v[104:107], v1, s[24:27], s32 offen offset:0 nt
    buffer_load_dwordx4 v[108:111], v1, s[24:27], s32 offen offset:256 nt
    s_cmp_lg_u32 s86, 1
    s_cbranch_scc1 L_nd44
    ds_write_b128 v4, v[40:43] offset:0
    ds_write_b128 v4, v[44:47] offset:1024
    ds_write_b128 v4, v[48:51] offset:2048
    ds_write_b128 v4, v[52:55] offset:3072
L_nd44:
    v_perm_b32 v9, v116, v112, s35
    v_perm_b32 v13, v116, v112, s36
    v_perm_b32 v17, v117, v113, s35
    v_perm_b32 v21, v117, v113, s36
    v_perm_b32 v25, v118, v114, s35
    v_perm_b32 v29, v118, v114, s36
    v_perm_b32 v33, v119, v115, s35
    v_perm_b32 v37, v119, v115, s36
    s_waitcnt vmcnt(26)
    buffer_load_dwordx4 v[112:115], v1, s[24:27], s32 offen offset:512 nt
    buffer_load_dwordx4 v[116:119], v1, s[24:27], s32 offen offset:768 nt
    s_cmp_lg_u32 s86, 1
    s_cbranch_scc1 L_nd45
    ds_write_b128 v4, v[56:59] offset:4096
    ds_write_b128 v4, v[60:63] offset:5120
    ds_write_b128 v4, v[64:67] offset:6144
    ds_write_b128 v4, v[68:71] offset:7168
    v_mov_b64 v[40:41], 0
    v_mov_b64 v[42:43], 0
    v_mov_b64 v[44:45], 0
    v_mov_b64 v[46:47], 0
    v_mov_b64 v[48:49], 0
    v_mov_b64 v[50:51], 0
    v_mov_b64 v[52:53], 0
    v_mov_b64 v[54:55], 0
L_nd45:
    v_perm_b32 v10, v124, v120, s35
    v_perm_b32 v14, v124, v120, s36
    v_perm_b32 v18, v125, v121, s35
    v_perm_b32 v22, v125, v121, s36
    v_perm_b32 v26, v126, v122, s35
    v_perm_b32 v30, v126, v122, s36
    v_perm_b32 v34, v127, v123, s35
    v_perm_b32 v38, v127, v123, s36
    s_waitcnt vmcnt(26)
    buffer_load_dwordx4 v[120:123], v1, s[24:27], s32 offen offset:1024 nt
    buffer_load_dwordx4 v[124:127], v1, s[24:27], s32 offen offset:1280 nt
    s_cmp_lg_u32 s86, 1
    s_cbranch_scc1 L_nd46
    v_mov_b64 v[56:57], 0
    v_mov_b64 v[58:59], 0
    v_mov_b64 v[60:61], 0
    v_mov_b64 v[62:63], 0
    v_mov_b64 v[64:65], 0
    v_mov_b64 v[66:67], 0
    v_mov_b64 v[68:69], 0
    v_mov_b64 v[70:71], 0
L_nd46:
    v_perm_b32 v11, v132, v128, s35
    v_perm_b32 v15, v132, v128, s36
    v_perm_b32 v19, v133, v129, s35
    v_mfma_f32_16x16x32_bf16 v[40:43], v[72:75], v[8:11], v[40:43]
    v_perm_b32 v23, v133, v129, s36
    v_perm_b32 v27, v134, v130, s35
    v_mfma_f32_16x16x32_bf16 v[44:47], v[72:75], v[12:15], v[44:47]
    v_perm_b32 v31, v134, v130, s36
    v_perm_b32 v35, v135, v131, s35
    v_mfma_f32_16x16x32_bf16 v[48:51], v[72:75], v[16:19], v[48:51]
    v_perm_b32 v39, v135, v131, s36
    v_mfma_f32_16x16x32_bf16 v[52:55], v[72:75], v[20:23], v[52:55]
    s_waitcnt vmcnt(26)
    buffer_load_dwordx4 v[128:131], v1, s[24:27], s32 offen offset:1536 nt
    buffer_load_dwordx4 v[132:135], v1, s[24:27], s32 offen offset:1792 nt
    v_mfma_f32_16x16x32_bf16 v[56:59], v[72:75], v[24:27], v[56:59]
    v_perm_b32 v8, v140, v136, s35
    v_perm_b32 v12, v140, v136, s36
    v_mfma_f32_16x16x32_bf16 v[60:63], v[72:75], v[28:31], v[60:63]
    v_perm_b32 v16, v141, v137, s35
    v_perm_b32 v20, v141, v137, s36
    v_mfma_f32_16x16x32_bf16 v[64:67], v[72:75], v[32:35], v[64:67]
    v_perm_b32 v24, v142, v138, s35
    v_perm_b32 v28, v142, v138, s36
    v_mfma_f32_16x16x32_bf16 v[68:71], v[72:75], v[36:39], v[68:71]
    v_perm_b32 v32, v143, v139, s35
    v_perm_b32 v36, v143, v139, s36
    s_waitcnt vmcnt(26)
    buffer_load_dwordx4 v[136:139], v1, s[24:27], s32 offen offset:2048 nt
    buffer_load_dwordx4 v[140:143], v1, s[24:27], s32 offen offset:2304 nt
    v_perm_b32 v9, v148, v144, s35
    v_perm_b32 v13, v148, v144, s36
    v_perm_b32 v17, v149, v145, s35
    v_perm_b32 v21, v149, v145, s36
    v_perm_b32 v25, v150, v146, s35
    v_perm_b32 v29, v150, v146, s36
    v_perm_b32 v33, v151, v147, s35
    v_perm_b32 v37, v151, v147, s36
    s_waitcnt vmcnt(26)
    buffer_load_dwordx4 v[144:147], v1, s[24:27], s32 offen offset:2560 nt
    buffer_load_dwordx4 v[148:151], v1, s[24:27], s32 offen offset:2816 nt
    v_perm_b32 v10, v156, v152, s35
    v_perm_b32 v14, v156, v152, s36
    v_perm_b32 v18, v157, v153, s35
    v_perm_b32 v22, v157, v153, s36
    v_perm_b32 v26, v158, v154, s35
    v_perm_b32 v30, v158, v154, s36
    v_perm_b32 v34, v159, v155, s35
    v_perm_b32 v38, v159, v155, s36
    s_waitcnt vmcnt(26)
    buffer_load_dwordx4 v[152:155], v1, s[24:27], s32 offen offset:3072 nt
    buffer_load_dwordx4 v[156:159], v1, s[24:27], s32 offen offset:3328 nt
    v_perm_b32 v11, v164, v160, s35
    v_perm_b32 v15, v164, v160, s36
    v_perm_b32 v19, v165, v161, s35
    v_mfma_f32_16x16x32_bf16 v[40:43], v[76:79], v[8:11], v[40:43]
    v_perm_b32 v23, v165, v161, s36
    v_perm_b32 v27, v166, v162, s35
    v_mfma_f32_16x16x32_bf16 v[44:47], v[76:79], v[12:15], v[44:47]
    v_perm_b32 v31, v166, v162, s36
    v_perm_b32 v35, v167, v163, s35
    v_mfma_f32_16x16x32_bf16 v[48:51], v[76:79], v[16:19], v[48:51]
    v_perm_b32 v39, v167, v163, s36
    v_mfma_f32_16x16x32_bf16 v[52:55], v[76:79], v[20:23], v[52:55]
    s_waitcnt vmcnt(26)
    buffer_load_dwordx4 v[160:163], v1, s[24:27], s32 offen offset:3584 nt
    buffer_load_dwordx4 v[164:167], v1, s[24:27], s32 offen offset:3840 nt
    v_mfma_f32_16x16x32_bf16 v[56:59], v[76:79], v[24:27], v[56:59]
    v_perm_b32 v8, v172, v168, s35
    v_perm_b32 v12, v172, v168, s36
    v_mfma_f32_16x16x32_bf16 v[60:63], v[76:79], v[28:31], v[60:63]
    v_perm_b32 v16, v173, v169, s35
    v_perm_b32 v20, v173, v169, s36
    v_mfma_f32_16x16x32_bf16 v[64:67], v[76:79], v[32:35], v[64:67]
    v_perm_b32 v24, v174, v170, s35
    v_perm_b32 v28, v174, v170, s36
    v_mfma_f32_16x16x32_bf16 v[68:71], v[76:79], v[36:39], v[68:71]
    v_perm_b32 v32, v175, v171, s35
    v_perm_b32 v36, v175, v171, s36
    s_waitcnt vmcnt(26)
    buffer_load_dwordx4 v[168:171], v2, s[24:27], s32 offen offset:0 nt
    buffer_load_dwordx4 v[172:175], v2, s[24:27], s32 offen offset:256 nt
    v_perm_b32 v9, v180, v176, s35
    v_perm_b32 v13, v180, v176, s36
    v_perm_b32 v17, v181, v177, s35
    v_perm_b32 v21, v181, v177, s36
    v_perm_b32 v25, v182, v178, s35
    v_perm_b32 v29, v182, v178, s36
    v_perm_b32 v33, v183, v179, s35
    v_perm_b32 v37, v183, v179, s36
    s_waitcnt vmcnt(26)
    buffer_load_dwordx4 v[176:179], v2, s[24:27], s32 offen offset:512 nt
    buffer_load_dwordx4 v[180:183], v2, s[24:27], s32 offen offset:768 nt
    v_perm_b32 v10, v188, v184, s35
    v_perm_b32 v14, v188, v184, s36
    v_perm_b32 v18, v189, v185, s35
    v_perm_b32 v22, v189, v185, s36
    v_perm_b32 v26, v190, v186, s35
    v_perm_b32 v30, v190, v186, s36
    v_perm_b32 v34, v191, v187, s35
    v_perm_b32 v38, v191, v187, s36
    s_waitcnt vmcnt(26)
    buffer_load_dwordx4 v[184:187], v2, s[24:27], s32 offen offset:1024 nt
    buffer_load_dwordx4 v[188:191], v2, s[24:27], s32 offen offset:1280 nt
    v_perm_b32 v11, v196, v192, s35
    v_perm_b32 v15, v196, v192, s36
    v_perm_b32 v19, v197, v193, s35
    v_mfma_f32_16x16x32_bf16 v[40:43], v[80:83], v[8:11], v[40:43]
    v_perm_b32 v23, v197, v193, s36
    v_perm_b32 v27, v198, v194, s35
    v_mfma_f32_16x16x32_bf16 v[44:47], v[80:83], v[12:15], v[44:47]
    v_perm_b32 v31, v198, v194, s36
    v_perm_b32 v35, v199, v195, s35
    v_mfma_f32_16x16x32_bf16 v[48:51], v[80:83], v[16:19], v[48:51]
    v_perm_b32 v39, v199, v195, s36
    v_mfma_f32_16x16x32_bf16 v[52:55], v[80:83], v[20:23], v[52:55]
    s_waitcnt vmcnt(21)
    buffer_load_dwordx4 v[192:195], v2, s[24:27], s32 offen offset:1536 nt
    buffer_load_dwordx4 v[196:199], v2, s[24:27], s32 offen offset:1792 nt
    v_mfma_f32_16x16x32_bf16 v[56:59], v[80:83], v[24:27], v[56:59]
    v_perm_b32 v8, v204, v200, s35
    v_perm_b32 v12, v204, v200, s36
    v_mfma_f32_16x16x32_bf16 v[60:63], v[80:83], v[28:31], v[60:63]
    v_perm_b32 v16, v205, v201, s35
    v_perm_b32 v20, v205, v201, s36
    v_mfma_f32_16x16x32_bf16 v[64:67], v[80:83], v[32:35], v[64:67]
    v_perm_b32 v24, v206, v202, s35
    v_perm_b32 v28, v206, v202, s36
    v_mfma_f32_16x16x32_bf16 v[68:71], v[80:83], v[36:39], v[68:71]
    v_perm_b32 v32, v207, v203, s35
    v_perm_b32 v36, v207, v203, s36
    s_waitcnt vmcnt(21)
    buffer_load_dwordx4 v[200:203], v2, s[24:27], s32 offen offset:2048 nt
    buffer_load_dwordx4 v[204:207], v2, s[24:27], s32 offen offset:2304 nt
    v_perm_b32 v9, v212, v208, s35
    v_perm_b32 v13, v212, v208, s36
    v_perm_b32 v17, v213, v209, s35
    v_perm_b32 v21, v213, v209, s36
    v_perm_b32 v25, v214, v210, s35
    v_perm_b32 v29, v214, v210, s36
    v_perm_b32 v33, v215, v211, s35
    v_perm_b32 v37, v215, v211, s36
    s_waitcnt vmcnt(21)
    buffer_load_dwordx4 v[208:211], v2, s[24:27], s32 offen offset:2560 nt
    buffer_load_dwordx4 v[212:215], v2, s[24:27], s32 offen offset:2816 nt
    v_perm_b32 v10, v220, v216, s35
    v_perm_b32 v14, v220, v216, s36
    v_perm_b32 v18, v221, v217, s35
    v_perm_b32 v22, v221, v217, s36
    v_perm_b32 v26, v222, v218, s35
    v_perm_b32 v30, v222, v218, s36
    v_perm_b32 v34, v223, v219, s35
    v_perm_b32 v38, v223, v219, s36
    s_waitcnt vmcnt(21)
    buffer_load_dwordx4 v[216:219], v2, s[24:27], s32 offen offset:3072 nt
    buffer_load_dwordx4 v[220:223], v2, s[24:27], s32 offen offset:3328 nt
    v_perm_b32 v11, v228, v224, s35
    v_perm_b32 v15, v228, v224, s36
    v_perm_b32 v19, v229, v225, s35
    v_mfma_f32_16x16x32_bf16 v[40:43], v[84:87], v[8:11], v[40:43]
    v_perm_b32 v23, v229, v225, s36
    v_perm_b32 v27, v230, v226, s35
    v_mfma_f32_16x16x32_bf16 v[44:47], v[84:87], v[12:15], v[44:47]
    v_perm_b32 v31, v230, v226, s36
    v_perm_b32 v35, v231, v227, s35
    v_mfma_f32_16x16x32_bf16 v[48:51], v[84:87], v[16:19], v[48:51]
    v_perm_b32 v39, v231, v227, s36
    v_mfma_f32_16x16x32_bf16 v[52:55], v[84:87], v[20:23], v[52:55]
    s_waitcnt vmcnt(21)
    buffer_load_dwordx4 v[224:227], v2, s[24:27], s32 offen offset:3584 nt
    buffer_load_dwordx4 v[228:231], v2, s[24:27], s32 offen offset:3840 nt
    s_add_u32 s34, s34, 1
    s_and_b32 s34, s34, 31
    s_and_b32 s3, s34, 3
    s_lshl_b32 s3, s3, 14
    s_lshr_b32 s32, s34, 2
    s_lshl_b32 s32, s32, 17
    s_or_b32 s32, s32, s3
    s_lshr_b32 s33, s32, 7
    s_add_u32 s39, s39, 1
    s_cmp_lg_u32 s39, 32
    s_cbranch_scc1 L_adv47
    s_add_u32 s24, s24, 2097152
    s_addc_u32 s25, s25, 0
    s_cmp_eq_u32 s51, 1
    s_cselect_b64 s[24:25], s[28:29], s[24:25]
    s_cselect_b64 s[20:21], s[12:13], s[20:21]
    s_mov_b32 s39, 0
    s_add_u32 s51, s51, 1
    s_cmp_ge_u32 s51, 4
    s_cselect_b32 s26, 0, s26
    s_cselect_b32 s22, 0, s22
L_adv47:
    s_cmp_eq_u32 s86, 0
    s_cbranch_scc1 L_np48
    s_mov_b32 s86, 0
    s_waitcnt lgkmcnt(0)
    s_barrier
L_np48:
    v_mfma_f32_16x16x32_bf16 v[56:59], v[84:87], v[24:27], v[56:59]
    v_perm_b32 v8, v108, v104, s35
    v_perm_b32 v12, v108, v104, s36
    v_mfma_f32_16x16x32_bf16 v[60:63], v[84:87], v[28:31], v[60:63]
    v_perm_b32 v16, v109, v105, s35
    v_perm_b32 v20, v109, v105, s36
    v_mfma_f32_16x16x32_bf16 v[64:67], v[84:87], v[32:35], v[64:67]
    v_perm_b32 v24, v110, v106, s35
    v_perm_b32 v28, v110, v106, s36
    v_mfma_f32_16x16x32_bf16 v[68:71], v[84:87], v[36:39], v[68:71]
    v_perm_b32 v32, v111, v107, s35
    v_perm_b32 v36, v111, v107, s36
    s_waitcnt vmcnt(21)
    buffer_load_dwordx4 v[72:75], v3, s[20:23], s33 offen offset:0
    buffer_load_dwordx4 v[76:79], v3, s[20:23], s33 offen offset:16
    buffer_load_dwordx4 v[80:83], v3, s[20:23], s33 offen offset:32
    buffer_load_dwordx4 v[84:87], v3, s[20:23], s33 offen offset:48
    buffer_load_dwordx4 v[104:107], v1, s[24:27], s32 offen offset:0 nt
    buffer_load_dwordx4 v[108:111], v1, s[24:27], s32 offen offset:256 nt
    v_perm_b32 v9, v116, v112, s35
    v_perm_b32 v13, v116, v112, s36
    v_perm_b32 v17, v117, v113, s35
    v_perm_b32 v21, v117, v113, s36
    v_perm_b32 v25, v118, v114, s35
    v_perm_b32 v29, v118, v114, s36
    v_perm_b32 v33, v119, v115, s35
    v_perm_b32 v37, v119, v115, s36
    s_waitcnt vmcnt(25)
    buffer_load_dwordx4 v[112:115], v1, s[24:27], s32 offen offset:512 nt
    buffer_load_dwordx4 v[116:119], v1, s[24:27], s32 offen offset:768 nt
    v_perm_b32 v10, v124, v120, s35
    v_perm_b32 v14, v124, v120, s36
    v_perm_b32 v18, v125, v121, s35
    v_perm_b32 v22, v125, v121, s36
    v_perm_b32 v26, v126, v122, s35
    v_perm_b32 v30, v126, v122, s36
    v_perm_b32 v34, v127, v123, s35
    v_perm_b32 v38, v127, v123, s36
    s_waitcnt vmcnt(25)
    buffer_load_dwordx4 v[120:123], v1, s[24:27], s32 offen offset:1024 nt
    buffer_load_dwordx4 v[124:127], v1, s[24:27], s32 offen offset:1280 nt
    v_perm_b32 v11, v132, v128, s35
    v_perm_b32 v15, v132, v128, s36
    v_perm_b32 v19, v133, v129, s35
    v_mfma_f32_16x16x32_bf16 v[40:43], v[88:91], v[8:11], v[40:43]
    v_perm_b32 v23, v133, v129, s36
    v_perm_b32 v27, v134, v130, s35
    v_mfma_f32_16x16x32_bf16 v[44:47], v[88:91], v[12:15], v[44:47]
    v_perm_b32 v31, v134, v130, s36
    v_perm_b32 v35, v135, v131, s35
    v_mfma_f32_16x16x32_bf16 v[48:51], v[88:91], v[16:19], v[48:51]
    v_perm_b32 v39, v135, v131, s36
    v_mfma_f32_16x16x32_bf16 v[52:55], v[88:91], v[20:23], v[52:55]
    s_waitcnt vmcnt(25)
    buffer_load_dwordx4 v[128:131], v1, s[24:27], s32 offen offset:1536 nt
    buffer_load_dwordx4 v[132:135], v1, s[24:27], s32 offen offset:1792 nt
    v_mfma_f32_16x16x32_bf16 v[56:59], v[88:91], v[24:27], v[56:59]
    v_perm_b32 v8, v140, v136, s35
    v_perm_b32 v12, v140, v136, s36
    v_mfma_f32_16x16x32_bf16 v[60:63], v[88:91], v[28:31], v[60:63]
    v_perm_b32 v16, v141, v137, s35
    v_perm_b32 v20, v141, v137, s36
    v_mfma_f32_16x16x32_bf16 v[64:67], v[88:91], v[32:35], v[64:67]
    v_perm_b32 v24, v142, v138, s35
    v_perm_b32 v28, v142, v138, s36
    v_mfma_f32_16x16x32_bf16 v[68:71], v[88:91], v[36:39], v[68:71]
    v_perm_b32 v32, v143, v139, s35
    v_perm_b32 v36, v143, v139, s36
    s_waitcnt vmcnt(25)
    buffer_load_dwordx4 v[136:139], v1, s[24:27], s32 offen offset:2048 nt
    buffer_load_dwordx4 v[140:143], v1, s[24:27], s32 offen offset:2304 nt
    v_perm_b32 v9, v148, v144, s35
    v_perm_b32 v13, v148, v144, s36
    v_perm_b32 v17, v149, v145, s35
    v_perm_b32 v21, v149, v145, s36
    v_perm_b32 v25, v150, v146, s35
    v_perm_b32 v29, v150, v146, s36
    v_perm_b32 v33, v151, v147, s35
    v_perm_b32 v37, v151, v147, s36
    s_waitcnt vmcnt(25)
    buffer_load_dwordx4 v[144:147], v1, s[24:27], s32 offen offset:2560 nt
    buffer_load_dwordx4 v[148:151], v1, s[24:27], s32 offen offset:2816 nt
    s_memrealtime s[80:81]
    s_add_u32 s87, s87, 1
    s_add_u32 s82, s82, 1721
    v_readlane_b32 s85, v232, s84
    v_perm_b32 v10, v156, v152, s35
    v_perm_b32 v14, v156, v152, s36
    v_perm_b32 v18, v157, v153, s35
    v_perm_b32 v22, v157, v153, s36
    v_perm_b32 v26, v158, v154, s35
    v_perm_b32 v30, v158, v154, s36
    v_perm_b32 v34, v159, v155, s35
    v_perm_b32 v38, v159, v155, s36
    s_waitcnt vmcnt(25)
    buffer_load_dwordx4 v[152:155], v1, s[24:27], s32 offen offset:3072 nt
    buffer_load_dwordx4 v[156:159], v1, s[24:27], s32 offen offset:3328 nt
    v_perm_b32 v11, v164, v160, s35
    v_perm_b32 v15, v164, v160, s36
    v_perm_b32 v19, v165, v161, s35
    v_mfma_f32_16x16x32_bf16 v[40:43], v[92:95], v[8:11], v[40:43]
    v_perm_b32 v23, v165, v161, s36
    v_perm_b32 v27, v166, v162, s35
    v_mfma_f32_16x16x32_bf16 v[44:47], v[92:95], v[12:15], v[44:47]
    v_perm_b32 v31, v166, v162, s36
    v_perm_b32 v35, v167, v163, s35
    v_mfma_f32_16x16x32_bf16 v[48:51], v[92:95], v[16:19], v[48:51]
    v_perm_b32 v39, v167, v163, s36
    v_mfma_f32_16x16x32_bf16 v[52:55], v[92:95], v[20:23], v[52:55]
    s_waitcnt vmcnt(25)
    buffer_load_dwordx4 v[160:163], v1, s[24:27], s32 offen offset:3584 nt
    buffer_load_dwordx4 v[164:167], v1, s[24:27], s32 offen offset:3840 nt
    v_mfma_f32_16x16x32_bf16 v[56:59], v[92:95], v[24:27], v[56:59]
    v_perm_b32 v8, v172, v168, s35
    v_perm_b32 v12, v172, v168, s36
    v_mfma_f32_16x16x32_bf16 v[60:63], v[92:95], v[28:31], v[60:63]
    v_perm_b32 v16, v173, v169, s35
    v_perm_b32 v20, v173, v169, s36
    v_mfma_f32_16x16x32_bf16 v[64:67], v[92:95], v[32:35], v[64:67]
    v_perm_b32 v24, v174, v170, s35
    v_perm_b32 v28, v174, v170, s36
    v_mfma_f32_16x16x32_bf16 v[68:71], v[92:95], v[36:39], v[68:71]
    v_perm_b32 v32, v175, v171, s35
    v_perm_b32 v36, v175, v171, s36
    s_waitcnt vmcnt(25)
    buffer_load_dwordx4 v[168:171], v2, s[24:27], s32 offen offset:0 nt
    buffer_load_dwordx4 v[172:175], v2, s[24:27], s32 offen offset:256 nt
    s_bfe_u32 s58, s85, 0x180003
    s_lshr_b32 s3, s85, 28
    s_cmp_eq_u32 s3, 8
    s_cselect_b32 s83, s58, s83
    s_cselect_b32 s98, 0, s98
    s_cselect_b32 s77, s76, s77
    s_addc_u32 s84, s84, 0
    s_bitcmp1_b64 s[94:95], s87
    s_cselect_b32 s98, 64, s98
    v_perm_b32 v9, v180, v176, s35
    v_perm_b32 v13, v180, v176, s36
    v_perm_b32 v17, v181, v177, s35
    v_perm_b32 v21, v181, v177, s36
    v_perm_b32 v25, v182, v178, s35
    v_perm_b32 v29, v182, v178, s36
    v_perm_b32 v33, v183, v179, s35
    v_perm_b32 v37, v183, v179, s36
    s_waitcnt vmcnt(25)
    buffer_load_dwordx4 v[176:179], v2, s[24:27], s32 offen offset:512 nt
    buffer_load_dwordx4 v[180:183], v2, s[24:27], s32 offen offset:768 nt
    s_lshr_b32 s3, s82, 3
    s_waitcnt lgkmcnt(0)
    s_sub_u32 s80, s80, s3
    s_sub_u32 s3, s80, s40
    s_mov_b32 s40, s80
    s_cmp_gt_i32 s3, 110
    s_cselect_b32 s3, s3, 0
    s_add_u32 s77, s77, s3
    s_add_u32 s76, s76, s3
    s_bitcmp1_b64 s[100:101], s87
    s_cselect_b32 s76, 0, s76
    s_sub_u32 s89, s80, s77
    s_sub_u32 s89, s89, s83
    s_bfe_i32 s89, s89, 0x180000
    s_bitcmp0_b64 s[90:91], s87
    s_cbranch_scc1 L_rp49
    s_and_b32 s92, s80, 0xffffff
    s_or_b32 s92, s92, 0x10000000
    s_atomic_add s92, s[78:79], s88
    s_add_u32 s88, s88, 4
L_rp49:
    v_perm_b32 v10, v188, v184, s35
    v_perm_b32 v14, v188, v184, s36
    v_perm_b32 v18, v189, v185, s35
    v_perm_b32 v22, v189, v185, s36
    v_perm_b32 v26, v190, v186, s35
    v_perm_b32 v30, v190, v186, s36
    v_perm_b32 v34, v191, v187, s35
    v_perm_b32 v38, v191, v187, s36
    s_waitcnt vmcnt(25)
    buffer_load_dwordx4 v[184:187], v2, s[24:27], s32 offen offset:1024 nt
    buffer_load_dwordx4 v[188:191], v2, s[24:27], s32 offen offset:1280 nt
    v_perm_b32 v11, v196, v192, s35
    v_perm_b32 v15, v196, v192, s36
    v_perm_b32 v19, v197, v193, s35
    v_mfma_f32_16x16x32_bf16 v[40:43], v[96:99], v[8:11], v[40:43]
    v_perm_b32 v23, v197, v193, s36
    v_perm_b32 v27, v198, v194, s35
    v_mfma_f32_16x16x32_bf16 v[44:47], v[96:99], v[12:15], v[44:47]
    v_perm_b32 v31, v198, v194, s36
    v_perm_b32 v35, v199, v195, s35
    v_mfma_f32_16x16x32_bf16 v[48:51], v[96:99], v[16:19], v[48:51]
    v_perm_b32 v39, v199, v195, s36
    v_mfma_f32_16x16x32_bf16 v[52:55], v[96:99], v[20:23], v[52:55]
    s_waitcnt vmcnt(21)
    buffer_load_dwordx4 v[192:195], v2, s[24:27], s32 offen offset:1536 nt
    buffer_load_dwordx4 v[196:199], v2, s[24:27], s32 offen offset:1792 nt
    v_mfma_f32_16x16x32_bf16 v[56:59], v[96:99], v[24:27], v[56:59]
    v_perm_b32 v8, v204, v200, s35
    v_perm_b32 v12, v204, v200, s36
    v_mfma_f32_16x16x32_bf16 v[60:63], v[96:99], v[28:31], v[60:63]
    v_perm_b32 v16, v205, v201, s35
    v_perm_b32 v20, v205, v201, s36
    v_mfma_f32_16x16x32_bf16 v[64:67], v[96:99], v[32:35], v[64:67]
    v_perm_b32 v24, v206, v202, s35
    v_perm_b32 v28, v206, v202, s36
    v_mfma_f32_16x16x32_bf16 v[68:71], v[96:99], v[36:39], v[68:71]
    v_perm_b32 v32, v207, v203, s35
    v_perm_b32 v36, v207, v203, s36
    s_waitcnt vmcnt(21)
    buffer_load_dwordx4 v[200:203], v2, s[24:27], s32 offen offset:2048 nt
    buffer_load_dwordx4 v[204:207], v2, s[24:27], s32 offen offset:2304 nt
    s_mov_b32 s93, 0
    s_cmp_ge_u32 s87, 52
    s_cselect_b32 s3, 1, 0
    s_lshl_b32 s89, s89, s3
    s_cmp_ge_i32 s89, -80
    s_addc_u32 s93, s93, 0
    s_cmp_ge_i32 s89, 80
    s_addc_u32 s93, s93, 0
    s_cmp_ge_i32 s89, 250
    s_addc_u32 s93, s93, 0
    s_cmp_eq_u32 s83, -1
    s_cselect_b32 s93, 1, s93
    s_cmp_lt_i32 s89, 80
    s_cselect_b32 s3, 5, 4
    s_cmp_ge_u32 s87, 63
    s_cselect_b32 s93, s3, s93
    v_perm_b32 v9, v212, v208, s35
    v_perm_b32 v13, v212, v208, s36
    v_perm_b32 v17, v213, v209, s35
    v_perm_b32 v21, v213, v209, s36
    v_perm_b32 v25, v214, v210, s35
    v_perm_b32 v29, v214, v210, s36
    v_perm_b32 v33, v215, v211, s35
    v_perm_b32 v37, v215, v211, s36
    s_waitcnt vmcnt(21)
    buffer_load_dwordx4 v[208:211], v2, s[24:27], s32 offen offset:2560 nt
    buffer_load_dwordx4 v[212:215], v2, s[24:27], s32 offen offset:2816 nt
    v_perm_b32 v10, v220, v216, s35
    v_perm_b32 v14, v220, v216, s36
    v_perm_b32 v18, v221, v217, s35
    v_perm_b32 v22, v221, v217, s36
    v_perm_b32 v26, v222, v218, s35
    v_perm_b32 v30, v222, v218, s36
    v_perm_b32 v34, v223, v219, s35
    v_perm_b32 v38, v223, v219, s36
    s_waitcnt vmcnt(21)
    buffer_load_dwordx4 v[216:219], v2, s[24:27], s32 offen offset:3072 nt
    buffer_load_dwordx4 v[220:223], v2, s[24:27], s32 offen offset:3328 nt
    v_perm_b32 v11, v228, v224, s35
    v_perm_b32 v15, v228, v224, s36
    v_perm_b32 v19, v229, v225, s35
    v_mfma_f32_16x16x32_bf16 v[40:43], v[100:103], v[8:11], v[40:43]
    v_perm_b32 v23, v229, v225, s36
    v_perm_b32 v27, v230, v226, s35
    v_mfma_f32_16x16x32_bf16 v[44:47], v[100:103], v[12:15], v[44:47]
    v_perm_b32 v31, v230, v226, s36
    v_perm_b32 v35, v231, v227, s35
    v_mfma_f32_16x16x32_bf16 v[48:51], v[100:103], v[16:19], v[48:51]
    v_perm_b32 v39, v231, v227, s36
    v_mfma_f32_16x16x32_bf16 v[52:55], v[100:103], v[20:23], v[52:55]
    s_waitcnt vmcnt(21)
    buffer_load_dwordx4 v[224:227], v2, s[24:27], s32 offen offset:3584 nt
    buffer_load_dwordx4 v[228:231], v2, s[24:27], s32 offen offset:3840 nt
    v_mfma_f32_16x16x32_bf16 v[56:59], v[100:103], v[24:27], v[56:59]
    v_mfma_f32_16x16x32_bf16 v[60:63], v[100:103], v[28:31], v[60:63]
    v_mfma_f32_16x16x32_bf16 v[64:67], v[100:103], v[32:35], v[64:67]
    v_mfma_f32_16x16x32_bf16 v[68:71], v[100:103], v[36:39], v[68:71]
    s_sub_u32 s38, s38, 1
    s_cbranch_scc1 L_v_done
    s_cmp_eq_u32 s93, 2
    s_cbranch_scc1 L_v2
    s_branch L_v_top
    .p2align 3
L_v3:
    s_add_u32 s34, s34, 1
    s_and_b32 s34, s34, 31
    s_and_b32 s3, s34, 3
    s_lshl_b32 s3, s3, 14
    s_lshr_b32 s32, s34, 2
    s_lshl_b32 s32, s32, 17
    s_or_b32 s32, s32, s3
    s_lshr_b32 s33, s32, 7
    s_add_u32 s39, s39, 1
    s_cmp_lg_u32 s39, 32
    s_cbranch_scc1 L_adv50
    s_add_u32 s24, s24, 2097152
    s_addc_u32 s25, s25, 0
    s_cmp_eq_u32 s51, 1
    s_cselect_b64 s[24:25], s[28:29], s[24:25]
    s_cselect_b64 s[20:21], s[12:13], s[20:21]
    s_mov_b32 s39, 0
    s_add_u32 s51, s51, 1
    s_cmp_ge_u32 s51, 4
    s_cselect_b32 s26, 0, s26
    s_cselect_b32 s22, 0, s22
L_adv50:
    s_waitcnt vmcnt(30)
    v_perm_b32 v8, v108, v104, s35
    v_perm_b32 v12, v108, v104, s36
    v_perm_b32 v16, v109, v105, s35
    v_perm_b32 v20, v109, v105, s36
    v_perm_b32 v24, v110, v106, s35
    v_perm_b32 v28, v110, v106, s36
    v_perm_b32 v32, v111, v107, s35
    v_perm_b32 v36, v111, v107, s36
    s_waitcnt vmcnt(25)
    buffer_load_dwordx4 v[88:91], v3, s[20:23], s33 offen offset:0
    buffer_load_dwordx4 v[92:95], v3, s[20:23], s33 offen offset:16
    buffer_load_dwordx4 v[96:99], v3, s[20:23], s33 offen offset:32
    buffer_load_dwordx4 v[100:103], v3, s[20:23], s33 offen offset:48
    buffer_load_dword v232, v233, s[96:99], 0 offen sc1
    buffer_load_dwordx4 v[104:107], v1, s[24:27], s32 offen offset:0 nt
    buffer_load_dwordx4 v[108:111], v1, s[24:27], s32 offen offset:256 nt
    s_cmp_lg_u32 s86, 1
    s_cbranch_scc1 L_nd51
    ds_write_b128 v4, v[40:43] offset:0
    ds_write_b128 v4, v[44:47] offset:1024
    ds_write_b128 v4, v[48:51] offset:2048
    ds_write_b128 v4, v[52:55] offset:3072
L_nd51:
    v_perm_b32 v9, v116, v112, s35
    v_perm_b32 v13, v116, v112, s36
    v_perm_b32 v17, v117, v113, s35
    v_perm_b32 v21, v117, v113, s36
    v_perm_b32 v25, v118, v114, s35
    v_perm_b32 v29, v118, v114, s36
    v_perm_b32 v33, v119, v115, s35
    v_perm_b32 v37, v119, v115, s36
    s_waitcnt vmcnt(30)
    buffer_load_dwordx4 v[112:115], v1, s[24:27], s32 offen offset:512 nt
    buffer_load_dwordx4 v[116:119], v1, s[24:27], s32 offen offset:768 nt
    s_cmp_lg_u32 s86, 1
    s_cbranch_scc1 L_nd52
    ds_write_b128 v4, v[56:59] offset:4096
    ds_write_b128 v4, v[60:63] offset:5120
    ds_write_b128 v4, v[64:67] offset:6144
    ds_write_b128 v4, v[68:71] offset:7168
    v_mov_b64 v[40:41], 0
    v_mov_b64 v[42:43], 0
    v_mov_b64 v[44:45], 0
    v_mov_b64 v[46:47], 0
    v_mov_b64 v[48:49], 0
    v_mov_b64 v[50:51], 0
    v_mov_b64 v[52:53], 0
    v_mov_b64 v[54:55], 0
L_nd52:
    v_perm_b32 v10, v124, v120, s35
    v_perm_b32 v14, v124, v120, s36
    v_perm_b32 v18, v125, v121, s35
    v_perm_b32 v22, v125, v121, s36
    v_perm_b32 v26, v126, v122, s35
    v_perm_b32 v30, v126, v122, s36
    v_perm_b32 v34, v127, v123, s35
    v_perm_b32 v38, v127, v123, s36
    s_waitcnt vmcnt(30)
    buffer_load_dwordx4 v[120:123], v1, s[24:27], s32 offen offset:1024 nt
    buffer_load_dwordx4 v[124:127], v1, s[24:27], s32 offen offset:1280 nt
    s_cmp_lg_u32 s86, 1
    s_cbranch_scc1 L_nd53
    v_mov_b64 v[56:57], 0
    v_mov_b64 v[58:59], 0
    v_mov_b64 v[60:61], 0
    v_mov_b64 v[62:63], 0
    v_mov_b64 v[64:65], 0
    v_mov_b64 v[66:67], 0
    v_mov_b64 v[68:69], 0
    v_mov_b64 v[70:71], 0
L_nd53:
    v_perm_b32 v11, v132, v128, s35
    v_perm_b32 v15, v132, v128, s36
    v_perm_b32 v19, v133, v129, s35
    v_mfma_f32_16x16x32_bf16 v[40:43], v[72:75], v[8:11], v[40:43]
    v_perm_b32 v23, v133, v129, s36
    v_perm_b32 v27, v134, v130, s35
    v_mfma_f32_16x16x32_bf16 v[44:47], v[72:75], v[12:15], v[44:47]
    v_perm_b32 v31, v134, v130, s36
    v_perm_b32 v35, v135, v131, s35
    v_mfma_f32_16x16x32_bf16 v[48:51], v[72:75], v[16:19], v[48:51]
    v_perm_b32 v39, v135, v131, s36
    v_mfma_f32_16x16x32_bf16 v[52:55], v[72:75], v[20:23], v[52:55]
    s_waitcnt vmcnt(30)
    buffer_load_dwordx4 v[128:131], v1, s[24:27], s32 offen offset:1536 nt
    buffer_load_dwordx4 v[132:135], v1, s[24:27], s32 offen offset:1792 nt
    v_mfma_f32_16x16x32_bf16 v[56:59], v[72:75], v[24:27], v[56:59]
    v_perm_b32 v8, v140, v136, s35
    v_perm_b32 v12, v140, v136, s36
    v_mfma_f32_16x16x32_bf16 v[60:63], v[72:75], v[28:31], v[60:63]
    v_perm_b32 v16, v141, v137, s35
    v_perm_b32 v20, v141, v137, s36
    v_mfma_f32_16x16x32_bf16 v[64:67], v[72:75], v[32:35], v[64:67]
    v_perm_b32 v24, v142, v138, s35
    v_perm_b32 v28, v142, v138, s36
    v_mfma_f32_16x16x32_bf16 v[68:71], v[72:75], v[36:39], v[68:71]
    v_perm_b32 v32, v143, v139, s35
    v_perm_b32 v36, v143, v139, s36
    s_waitcnt vmcnt(30)
    buffer_load_dwordx4 v[136:139], v1, s[24:27], s32 offen offset:2048 nt
    buffer_load_dwordx4 v[140:143], v1, s[24:27], s32 offen offset:2304 nt
    v_perm_b32 v9, v148, v144, s35
    v_perm_b32 v13, v148, v144, s36
    v_perm_b32 v17, v149, v145, s35
    v_perm_b32 v21, v149, v145, s36
    v_perm_b32 v25, v150, v146, s35
    v_perm_b32 v29, v150, v146, s36
    v_perm_b32 v33, v151, v147, s35
    v_perm_b32 v37, v151, v147, s36
    s_waitcnt vmcnt(30)
    buffer_load_dwordx4 v[144:147], v1, s[24:27], s32 offen offset:2560 nt
    buffer_load_dwordx4 v[148:151], v1, s[24:27], s32 offen offset:2816 nt
    v_perm_b32 v10, v156, v152, s35
    v_perm_b32 v14, v156, v152, s36
    v_perm_b32 v18, v157, v153, s35
    v_perm_b32 v22, v157, v153, s36
    v_perm_b32 v26, v158, v154, s35
    v_perm_b32 v30, v158, v154, s36
    v_perm_b32 v34, v159, v155, s35
    v_perm_b32 v38, v159, v155, s36
    s_waitcnt vmcnt(30)
    buffer_load_dwordx4 v[152:155], v1, s[24:27], s32 offen offset:3072 nt
    buffer_load_dwordx4 v[156:159], v1, s[24:27], s32 offen offset:3328 nt
    v_perm_b32 v11, v164, v160, s35
    v_perm_b32 v15, v164, v160, s36
    v_perm_b32 v19, v165, v161, s35
    v_mfma_f32_16x16x32_bf16 v[40:43], v[76:79], v[8:11], v[40:43]
    v_perm_b32 v23, v165, v161, s36
    v_perm_b32 v27, v166, v162, s35
    v_mfma_f32_16x16x32_bf16 v[44:47], v[76:79], v[12:15], v[44:47]
    v_perm_b32 v31, v166, v162, s36
    v_perm_b32 v35, v167, v163, s35
    v_mfma_f32_16x16x32_bf16 v[48:51], v[76:79], v[16:19], v[48:51]
    v_perm_b32 v39, v167, v163, s36
    v_mfma_f32_16x16x32_bf16 v[52:55], v[76:79], v[20:23], v[52:55]
    s_waitcnt vmcnt(30)
    buffer_load_dwordx4 v[160:163], v1, s[24:27], s32 offen offset:3584 nt
    buffer_load_dwordx4 v[164:167], v1, s[24:27], s32 offen offset:3840 nt
    v_mfma_f32_16x16x32_bf16 v[56:59], v[76:79], v[24:27], v[56:59]
    v_perm_b32 v8, v172, v168, s35
    v_perm_b32 v12, v172, v168, s36
    v_mfma_f32_16x16x32_bf16 v[60:63], v[76:79], v[28:31], v[60:63]
    v_perm_b32 v16, v173, v169, s35
    v_perm_b32 v20, v173, v169, s36
    v_mfma_f32_16x16x32_bf16 v[64:67], v[76:79], v[32:35], v[64:67]
    v_perm_b32 v24, v174, v170, s35
    v_perm_b32 v28, v174, v170, s36
    v_mfma_f32_16x16x32_bf16 v[68:71], v[76:79], v[36:39], v[68:71]
    v_perm_b32 v32, v175, v171, s35
    v_perm_b32 v36, v175, v171, s36
    s_waitcnt vmcnt(30)
    buffer_load_dwordx4 v[168:171], v2, s[24:27], s32 offen offset:0 nt
    buffer_load_dwordx4 v[172:175], v2, s[24:27], s32 offen offset:256 nt
    v_perm_b32 v9, v180, v176, s35
    v_perm_b32 v13, v180, v176, s36
    v_perm_b32 v17, v181, v177, s35
    v_perm_b32 v21, v181, v177, s36
    v_perm_b32 v25, v182, v178, s35
    v_perm_b32 v29, v182, v178, s36
    v_perm_b32 v33, v183, v179, s35
    v_perm_b32 v37, v183, v179, s36
    s_waitcnt vmcnt(30)
    buffer_load_dwordx4 v[176:179], v2, s[24:27], s32 offen offset:512 nt
    buffer_load_dwordx4 v[180:183], v2, s[24:27], s32 offen offset:768 nt
    v_perm_b32 v10, v188, v184, s35
    v_perm_b32 v14, v188, v184, s36
    v_perm_b32 v18, v189, v185, s35
    v_perm_b32 v22, v189, v185, s36
    v_perm_b32 v26, v190, v186, s35
    v_perm_b32 v30, v190, v186, s36
    v_perm_b32 v34, v191, v187, s35
    v_perm_b32 v38, v191, v187, s36
    s_waitcnt vmcnt(30)
    buffer_load_dwordx4 v[184:187], v2, s[24:27], s32 offen offset:1024 nt
    buffer_load_dwordx4 v[188:191], v2, s[24:27], s32 offen offset:1280 nt
    v_perm_b32 v11, v196, v192, s35
    v_perm_b32 v15, v196, v192, s36
    v_perm_b32 v19, v197, v193, s35
    v_mfma_f32_16x16x32_bf16 v[40:43], v[80:83], v[8:11], v[40:43]
    v_perm_b32 v23, v197, v193, s36
    v_perm_b32 v27, v198, v194, s35
    v_mfma_f32_16x16x32_bf16 v[44:47], v[80:83], v[12:15], v[44:47]
    v_perm_b32 v31, v198, v194, s36
    v_perm_b32 v35, v199, v195, s35
    v_mfma_f32_16x16x32_bf16 v[48:51], v[80:83], v[16:19], v[48:51]
    v_perm_b32 v39, v199, v195, s36
    v_mfma_f32_16x16x32_bf16 v[52:55], v[80:83], v[20:23], v[52:55]
    s_waitcnt vmcnt(30)
    buffer_load_dwordx4 v[192:195], v2, s[24:27], s32 offen offset:1536 nt
    buffer_load_dwordx4 v[196:199], v2, s[24:27], s32 offen offset:1792 nt
    v_mfma_f32_16x16x32_bf16 v[56:59], v[80:83], v[24:27], v[56:59]
    v_perm_b32 v8, v204, v200, s35
    v_perm_b32 v12, v204, v200, s36
    v_mfma_f32_16x16x32_bf16 v[60:63], v[80:83], v[28:31], v[60:63]
    v_perm_b32 v16, v205, v201, s35
    v_perm_b32 v20, v205, v201, s36
    v_mfma_f32_16x16x32_bf16 v[64:67], v[80:83], v[32:35], v[64:67]
    v_perm_b32 v24, v206, v202, s35
    v_perm_b32 v28, v206, v202, s36
    v_mfma_f32_16x16x32_bf16 v[68:71], v[80:83], v[36:39], v[68:71]
    v_perm_b32 v32, v207, v203, s35
    v_perm_b32 v36, v207, v203, s36
    s_waitcnt vmcnt(30)
    buffer_load_dwordx4 v[200:203], v2, s[24:27], s32 offen offset:2048 nt
    buffer_load_dwordx4 v[204:207], v2, s[24:27], s32 offen offset:2304 nt
    v_perm_b32 v9, v212, v208, s35
    v_perm_b32 v13, v212, v208, s36
    v_perm_b32 v17, v213, v209, s35
    v_perm_b32 v21, v213, v209, s36
    v_perm_b32 v25, v214, v210, s35
    v_perm_b32 v29, v214, v210, s36
    v_perm_b32 v33, v215, v211, s35
    v_perm_b32 v37, v215, v211, s36
    s_waitcnt vmcnt(25)
    buffer_load_dwordx4 v[208:211], v2, s[24:27], s32 offen offset:2560 nt
    buffer_load_dwordx4 v[212:215], v2, s[24:27], s32 offen offset:2816 nt
    v_perm_b32 v10, v220, v216, s35
    v_perm_b32 v14, v220, v216, s36
    v_perm_b32 v18, v221, v217, s35
    v_perm_b32 v22, v221, v217, s36
    v_perm_b32 v26, v222, v218, s35
    v_perm_b32 v30, v222, v218, s36
    v_perm_b32 v34, v223, v219, s35
    v_perm_b32 v38, v223, v219, s36
    s_waitcnt vmcnt(25)
    buffer_load_dwordx4 v[216:219], v2, s[24:27], s32 offen offset:3072 nt
    buffer_load_dwordx4 v[220:223], v2, s[24:27], s32 offen offset:3328 nt
    v_perm_b32 v11, v228, v224, s35
    v_perm_b32 v15, v228, v224, s36
    v_perm_b32 v19, v229, v225, s35
    v_mfma_f32_16x16x32_bf16 v[40:43], v[84:87], v[8:11], v[40:43]
    v_perm_b32 v23, v229, v225, s36
    v_perm_b32 v27, v230, v226, s35
    v_mfma_f32_16x16x32_bf16 v[44:47], v[84:87], v[12:15], v[44:47]
    v_perm_b32 v31, v230, v226, s36
    v_perm_b32 v35, v231, v227, s35
    v_mfma_f32_16x16x32_bf16 v[48:51], v[84:87], v[16:19], v[48:51]
    v_perm_b32 v39, v231, v227, s36
    v_mfma_f32_16x16x32_bf16 v[52:55], v[84:87], v[20:23], v[52:55]
    s_waitcnt vmcnt(25)
    buffer_load_dwordx4 v[224:227], v2, s[24:27], s32 offen offset:3584 nt
    buffer_load_dwordx4 v[228:231], v2, s[24:27], s32 offen offset:3840 nt
    s_add_u32 s34, s34, 1
    s_and_b32 s34, s34, 31
    s_and_b32 s3, s34, 3
    s_lshl_b32 s3, s3, 14
    s_lshr_b32 s32, s34, 2
    s_lshl_b32 s32, s32, 17
    s_or_b32 s32, s32, s3
    s_lshr_b32 s33, s32, 7
    s_add_u32 s39, s39, 1
    s_cmp_lg_u32 s39, 32
    s_cbranch_scc1 L_adv54
    s_add_u32 s24, s24, 2097152
    s_addc_u32 s25, s25, 0
    s_cmp_eq_u32 s51, 1
    s_cselect_b64 s[24:25], s[28:29], s[24:25]
    s_cselect_b64 s[20:21], s[12:13], s[20:21]
    s_mov_b32 s39, 0
    s_add_u32 s51, s51, 1
    s_cmp_ge_u32 s51, 4
    s_cselect_b32 s26, 0, s26
    s_cselect_b32 s22, 0, s22
L_adv54:
    s_cmp_eq_u32 s86, 0
    s_cbranch_scc1 L_np55
    s_mov_b32 s86, 0
    s_waitcnt lgkmcnt(0)
    s_barrier
L_np55:
    v_mfma_f32_16x16x32_bf16 v[56:59], v[84:87], v[24:27], v[56:59]
    v_perm_b32 v8, v108, v104, s35
    v_perm_b32 v12, v108, v104, s36
    v_mfma_f32_16x16x32_bf16 v[60:63], v[84:87], v[28:31], v[60:63]
    v_perm_b32 v16, v109, v105, s35
    v_perm_b32 v20, v109, v105, s36
    v_mfma_f32_16x16x32_bf16 v[64:67], v[84:87], v[32:35], v[64:67]
    v_perm_b32 v24, v110, v106, s35
    v_perm_b32 v28, v110, v106, s36
    v_mfma_f32_16x16x32_bf16 v[68:71], v[84:87], v[36:39], v[68:71]
    v_perm_b32 v32, v111, v107, s35
    v_perm_b32 v36, v111, v107, s36
    s_waitcnt vmcnt(25)
    buffer_load_dwordx4 v[72:75], v3, s[20:23], s33 offen offset:0
    buffer_load_dwordx4 v[76:79], v3, s[20:23], s33 offen offset:16
    buffer_load_dwordx4 v[80:83], v3, s[20:23], s33 offen offset:32
    buffer_load_dwordx4 v[84:87], v3, s[20:23], s33 offen offset:48
    buffer_load_dwordx4 v[104:107], v1, s[24:27], s32 offen offset:0 nt
    buffer_load_dwordx4 v[108:111], v1, s[24:27], s32 offen offset:256 nt
    v_perm_b32 v9, v116, v112, s35
    v_perm_b32 v13, v116, v112, s36
    v_perm_b32 v17, v117, v113, s35
    v_perm_b32 v21, v117, v113, s36
    v_perm_b32 v25, v118, v114, s35
    v_perm_b32 v29, v118, v114, s36
    v_perm_b32 v33, v119, v115, s35
    v_perm_b32 v37, v119, v115, s36
    s_waitcnt vmcnt(29)
    buffer_load_dwordx4 v[112:115], v1, s[24:27], s32 offen offset:512 nt
    buffer_load_dwordx4 v[116:119], v1, s[24:27], s32 offen offset:768 nt
    v_perm_b32 v10, v124, v120, s35
    v_perm_b32 v14, v124, v120, s36
    v_perm_b32 v18, v125, v121, s35
    v_perm_b32 v22, v125, v121, s36
    v_perm_b32 v26, v126, v122, s35
    v_perm_b32 v30, v126, v122, s36
    v_perm_b32 v34, v127, v123, s35
    v_perm_b32 v38, v127, v123, s36
    s_waitcnt vmcnt(29)
    buffer_load_dwordx4 v[120:123], v1, s[24:27], s32 offen offset:1024 nt
    buffer_load_dwordx4 v[124:127], v1, s[24:27], s32 offen offset:1280 nt
    v_perm_b32 v11, v132, v128, s35
    v_perm_b32 v15, v132, v128, s36
    v_perm_b32 v19, v133, v129, s35
    v_mfma_f32_16x16x32_bf16 v[40:43], v[88:91], v[8:11], v[40:43]
    v_perm_b32 v23, v133, v129, s36
    v_perm_b32 v27, v134, v130, s35
    v_mfma_f32_16x16x32_bf16 v[44:47], v[88:91], v[12:15], v[44:47]
    v_perm_b32 v31, v134, v130, s36
    v_perm_b32 v35, v135, v131, s35
    v_mfma_f32_16x16x32_bf16 v[48:51], v[88:91], v[16:19], v[48:51]
    v_perm_b32 v39, v135, v131, s36
    v_mfma_f32_16x16x32_bf16 v[52:55], v[88:91], v[20:23], v[52:55]
    s_waitcnt vmcnt(29)
    buffer_load_dwordx4 v[128:131], v1, s[24:27], s32 offen offset:1536 nt
    buffer_load_dwordx4 v[132:135], v1, s[24:27], s32 offen offset:1792 nt
    v_mfma_f32_16x16x32_bf16 v[56:59], v[88:91], v[24:27], v[56:59]
    v_perm_b32 v8, v140, v136, s35
    v_perm_b32 v12, v140, v136, s36
    v_mfma_f32_16x16x32_bf16 v[60:63], v[88:91], v[28:31], v[60:63]
    v_perm_b32 v16, v141, v137, s35
    v_perm_b32 v20, v141, v137, s36
    v_mfma_f32_16x16x32_bf16 v[64:67], v[88:91], v[32:35], v[64:67]
    v_perm_b32 v24, v142, v138, s35
    v_perm_b32 v28, v142, v138, s36
    v_mfma_f32_16x16x32_bf16 v[68:71], v[88:91], v[36:39], v[68:71]
    v_perm_b32 v32, v143, v139, s35
    v_perm_b32 v36, v143, v139, s36
    s_waitcnt vmcnt(29)
    buffer_load_dwordx4 v[136:139], v1, s[24:27], s32 offen offset:2048 nt
    buffer_load_dwordx4 v[140:143], v1, s[24:27], s32 offen offset:2304 nt
    v_perm_b32 v9, v148, v144, s35
    v_perm_b32 v13, v148, v144, s36
    v_perm_b32 v17, v149, v145, s35
    v_perm_b32 v21, v149, v145, s36
    v_perm_b32 v25, v150, v146, s35
    v_perm_b32 v29, v150, v146, s36
    v_perm_b32 v33, v151, v147, s35
    v_perm_b32 v37, v151, v147, s36
    s_waitcnt vmcnt(29)
    buffer_load_dwordx4 v[144:147], v1, s[24:27], s32 offen offset:2560 nt
    buffer_load_dwordx4 v[148:151], v1, s[24:27], s32 offen offset:2816 nt
    s_memrealtime s[80:81]
    s_add_u32 s87, s87, 1
    s_add_u32 s82, s82, 1721
    v_readlane_b32 s85, v232, s84
    v_perm_b32 v10, v156, v152, s35
    v_perm_b32 v14, v156, v152, s36
    v_perm_b32 v18, v157, v153, s35
    v_perm_b32 v22, v157, v153, s36
    v_perm_b32 v26, v158, v154, s35
    v_perm_b32 v30, v158, v154, s36
    v_perm_b32 v34, v159, v155, s35
    v_perm_b32 v38, v159, v155, s36
    s_waitcnt vmcnt(29)
    buffer_load_dwordx4 v[152:155], v1, s[24:27], s32 offen offset:3072 nt
    buffer_load_dwordx4 v[156:159], v1, s[24:27], s32 offen offset:3328 nt
    v_perm_b32 v11, v164, v160, s35
    v_perm_b32 v15, v164, v160, s36
    v_perm_b32 v19, v165, v161, s35
    v_mfma_f32_16x16x32_bf16 v[40:43], v[92:95], v[8:11], v[40:43]
    v_perm_b32 v23, v165, v161, s36
    v_perm_b32 v27, v166, v162, s35
    v_mfma_f32_16x16x32_bf16 v[44:47], v[92:95], v[12:15], v[44:47]
    v_perm_b32 v31, v166, v162, s36
    v_perm_b32 v35, v167, v163, s35
    v_mfma_f32_16x16x32_bf16 v[48:51], v[92:95], v[16:19], v[48:51]
    v_perm_b32 v39, v167, v163, s36
    v_mfma_f32_16x16x32_bf16 v[52:55], v[92:95], v[20:23], v[52:55]
    s_waitcnt vmcnt(29)
    buffer_load_dwordx4 v[160:163], v1, s[24:27], s32 offen offset:3584 nt
    buffer_load_dwordx4 v[164:167], v1, s[24:27], s32 offen offset:3840 nt
    v_mfma_f32_16x16x32_bf16 v[56:59], v[92:95], v[24:27], v[56:59]
    v_perm_b32 v8, v172, v168, s35
    v_perm_b32 v12, v172, v168, s36
    v_mfma_f32_16x16x32_bf16 v[60:63], v[92:95], v[28:31], v[60:63]
    v_perm_b32 v16, v173, v169, s35
    v_perm_b32 v20, v173, v169, s36
    v_mfma_f32_16x16x32_bf16 v[64:67], v[92:95], v[32:35], v[64:67]
    v_perm_b32 v24, v174, v170, s35
    v_perm_b32 v28, v174, v170, s36
    v_mfma_f32_16x16x32_bf16 v[68:71], v[92:95], v[36:39], v[68:71]
    v_perm_b32 v32, v175, v171, s35
    v_perm_b32 v36, v175, v171, s36
    s_waitcnt vmcnt(29)
    buffer_load_dwordx4 v[168:171], v2, s[24:27], s32 offen offset:0 nt
    buffer_load_dwordx4 v[172:175], v2, s[24:27], s32 offen offset:256 nt
    s_bfe_u32 s58, s85, 0x180003
    s_lshr_b32 s3, s85, 28
    s_cmp_eq_u32 s3, 8
    s_cselect_b32 s83, s58, s83
    s_cselect_b32 s98, 0, s98
    s_cselect_b32 s77, s76, s77
    s_addc_u32 s84, s84, 0
    s_bitcmp1_b64 s[94:95], s87
    s_cselect_b32 s98, 64, s98
    v_perm_b32 v9, v180, v176, s35
    v_perm_b32 v13, v180, v176, s36
    v_perm_b32 v17, v181, v177, s35
    v_perm_b32 v21, v181, v177, s36
    v_perm_b32 v25, v182, v178, s35
    v_perm_b32 v29, v182, v178, s36
    v_perm_b32 v33, v183, v179, s35
    v_perm_b32 v37, v183, v179, s36
    s_waitcnt vmcnt(29)
    buffer_load_dwordx4 v[176:179], v2, s[24:27], s32 offen offset:512 nt
    buffer_load_dwordx4 v[180:183], v2, s[24:27], s32 offen offset:768 nt
    s_lshr_b32 s3, s82, 3
    s_waitcnt lgkmcnt(0)
    s_sub_u32 s80, s80, s3
    s_sub_u32 s3, s80, s40
    s_mov_b32 s40, s80
    s_cmp_gt_i32 s3, 110
    s_cselect_b32 s3, s3, 0
    s_add_u32 s77, s77, s3
    s_add_u32 s76, s76, s3
    s_bitcmp1_b64 s[100:101], s87
    s_cselect_b32 s76, 0, s76
    s_sub_u32 s89, s80, s77
    s_sub_u32 s89, s89, s83
    s_bfe_i32 s89, s89, 0x180000
    s_bitcmp0_b64 s[90:91], s87
    s_cbranch_scc1 L_rp56
    s_and_b32 s92, s80, 0xffffff
    s_or_b32 s92, s92, 0x10000000
    s_atomic_add s92, s[78:79], s88
    s_add_u32 s88, s88, 4
L_rp56:
    v_perm_b32 v10, v188, v184, s35
    v_perm_b32 v14, v188, v184, s36
    v_perm_b32 v18, v189, v185, s35
    v_perm_b32 v22, v189, v185, s36
    v_perm_b32 v26, v190, v186, s35
    v_perm_b32 v30, v190, v186, s36
    v_perm_b32 v34, v191, v187, s35
    v_perm_b32 v38, v191, v187, s36
    s_waitcnt vmcnt(29)
    buffer_load_dwordx4 v[184:187], v2, s[24:27], s32 offen offset:1024 nt
    buffer_load_dwordx4 v[188:191], v2, s[24:27], s32 offen offset:1280 nt
    v_perm_b32 v11, v196, v192, s35
    v_perm_b32 v15, v196, v192, s36
    v_perm_b32 v19, v197, v193, s35
    v_mfma_f32_16x16x32_bf16 v[40:43], v[96:99], v[8:11], v[40:43]
    v_perm_b32 v23, v197, v193, s36
    v_perm_b32 v27, v198, v194, s35
    v_mfma_f32_16x16x32_bf16 v[44:47], v[96:99], v[12:15], v[44:47]
    v_perm_b32 v31, v198, v194, s36
    v_perm_b32 v35, v199, v195, s35
    v_mfma_f32_16x16x32_bf16 v[48:51], v[96:99], v[16:19], v[48:51]
    v_perm_b32 v39, v199, v195, s36
    v_mfma_f32_16x16x32_bf16 v[52:55], v[96:99], v[20:23], v[52:55]
    s_waitcnt vmcnt(29)
    buffer_load_dwordx4 v[192:195], v2, s[24:27], s32 offen offset:1536 nt
    buffer_load_dwordx4 v[196:199], v2, s[24:27], s32 offen offset:1792 nt
    v_mfma_f32_16x16x32_bf16 v[56:59], v[96:99], v[24:27], v[56:59]
    v_perm_b32 v8, v204, v200, s35
    v_perm_b32 v12, v204, v200, s36
    v_mfma_f32_16x16x32_bf16 v[60:63], v[96:99], v[28:31], v[60:63]
    v_perm_b32 v16, v205, v201, s35
    v_perm_b32 v20, v205, v201, s36
    v_mfma_f32_16x16x32_bf16 v[64:67], v[96:99], v[32:35], v[64:67]
    v_perm_b32 v24, v206, v202, s35
    v_perm_b32 v28, v206, v202, s36
    v_mfma_f32_16x16x32_bf16 v[68:71], v[96:99], v[36:39], v[68:71]
    v_perm_b32 v32, v207, v203, s35
    v_perm_b32 v36, v207, v203, s36
    s_waitcnt vmcnt(29)
    buffer_load_dwordx4 v[200:203], v2, s[24:27], s32 offen offset:2048 nt
    buffer_load_dwordx4 v[204:207], v2, s[24:27], s32 offen offset:2304 nt
    s_mov_b32 s93, 0
    s_cmp_ge_u32 s87, 52
    s_cselect_b32 s3, 1, 0
    s_lshl_b32 s89, s89, s3
    s_cmp_ge_i32 s89, -80
    s_addc_u32 s93, s93, 0
    s_cmp_ge_i32 s89, 80
    s_addc_u32 s93, s93, 0
    s_cmp_ge_i32 s89, 250
    s_addc_u32 s93, s93, 0
    s_cmp_eq_u32 s83, -1
    s_cselect_b32 s93, 1, s93
    s_cmp_lt_i32 s89, 80
    s_cselect_b32 s3, 5, 4
    s_cmp_ge_u32 s87, 63
    s_cselect_b32 s93, s3, s93
    v_perm_b32 v9, v212, v208, s35
    v_perm_b32 v13, v212, v208, s36
    v_perm_b32 v17, v213, v209, s35
    v_perm_b32 v21, v213, v209, s36
    v_perm_b32 v25, v214, v210, s35
    v_perm_b32 v29, v214, v210, s36
    v_perm_b32 v33, v215, v211, s35
    v_perm_b32 v37, v215, v211, s36
    s_waitcnt vmcnt(25)
    buffer_load_dwordx4 v[208:211], v2, s[24:27], s32 offen offset:2560 nt
    buffer_load_dwordx4 v[212:215], v2, s[24:27], s32 offen offset:2816 nt
    v_perm_b32 v10, v220, v216, s35
    v_perm_b32 v14, v220, v216, s36
    v_perm_b32 v18, v221, v217, s35
    v_perm_b32 v22, v221, v217, s36
    v_perm_b32 v26, v222, v218, s35
    v_perm_b32 v30, v222, v218, s36
    v_perm_b32 v34, v223, v219, s35
    v_perm_b32 v38, v223, v219, s36
    s_waitcnt vmcnt(25)
    buffer_load_dwordx4 v[216:219], v2, s[24:27], s32 offen offset:3072 nt
    buffer_load_dwordx4 v[220:223], v2, s[24:27], s32 offen offset:3328 nt
    v_perm_b32 v11, v228, v224, s35
    v_perm_b32 v15, v228, v224, s36
    v_perm_b32 v19, v229, v225, s35
    v_mfma_f32_16x16x32_bf16 v[40:43], v[100:103], v[8:11], v[40:43]
    v_perm_b32 v23, v229, v225, s36
    v_perm_b32 v27, v230, v226, s35
    v_mfma_f32_16x16x32_bf16 v[44:47], v[100:103], v[12:15], v[44:47]
    v_perm_b32 v31, v230, v226, s36
    v_perm_b32 v35, v231, v227, s35
    v_mfma_f32_16x16x32_bf16 v[48:51], v[100:103], v[16:19], v[48:51]
    v_perm_b32 v39, v231, v227, s36
    v_mfma_f32_16x16x32_bf16 v[52:55], v[100:103], v[20:23], v[52:55]
    s_waitcnt vmcnt(25)
    buffer_load_dwordx4 v[224:227], v2, s[24:27], s32 offen offset:3584 nt
    buffer_load_dwordx4 v[228:231], v2, s[24:27], s32 offen offset:3840 nt
    v_mfma_f32_16x16x32_bf16 v[56:59], v[100:103], v[24:27], v[56:59]
    v_mfma_f32_16x16x32_bf16 v[60:63], v[100:103], v[28:31], v[60:63]
    v_mfma_f32_16x16x32_bf16 v[64:67], v[100:103], v[32:35], v[64:67]
    v_mfma_f32_16x16x32_bf16 v[68:71], v[100:103], v[36:39], v[68:71]
    s_sub_u32 s38, s38, 1
    s_cbranch_scc1 L_v_done
    s_cmp_eq_u32 s93, 3
    s_cbranch_scc1 L_v3
    s_branch L_v_top
    .p2align 3
L_v4:
    s_add_u32 s34, s34, 1
    s_and_b32 s34, s34, 31
    s_and_b32 s3, s34, 3
    s_lshl_b32 s3, s3, 14
    s_lshr_b32 s32, s34, 2
    s_lshl_b32 s32, s32, 17
    s_or_b32 s32, s32, s3
    s_lshr_b32 s33, s32, 7
    s_add_u32 s39, s39, 1
    s_cmp_lg_u32 s39, 32
    s_cbranch_scc1 L_adv57
    s_add_u32 s24, s24, 2097152
    s_addc_u32 s25, s25, 0
    s_cmp_eq_u32 s51, 1
    s_cselect_b64 s[24:25], s[28:29], s[24:25]
    s_cselect_b64 s[20:21], s[12:13], s[20:21]
    s_mov_b32 s39, 0
    s_add_u32 s51, s51, 1
    s_cmp_ge_u32 s51, 4
    s_cselect_b32 s26, 0, s26
    s_cselect_b32 s22, 0, s22
L_adv57:
    s_waitcnt vmcnt(30)
    v_perm_b32 v8, v108, v104, s35
    v_perm_b32 v12, v108, v104, s36
    v_perm_b32 v16, v109, v105, s35
    v_perm_b32 v20, v109, v105, s36
    v_perm_b32 v24, v110, v106, s35
    v_perm_b32 v28, v110, v106, s36
    v_perm_b32 v32, v111, v107, s35
    v_perm_b32 v36, v111, v107, s36
    buffer_load_dwordx4 v[88:91], v3, s[20:23], s33 offen offset:0
    buffer_load_dwordx4 v[92:95], v3, s[20:23], s33 offen offset:16
    buffer_load_dwordx4 v[96:99], v3, s[20:23], s33 offen offset:32
    buffer_load_dwordx4 v[100:103], v3, s[20:23], s33 offen offset:48
    buffer_load_dword v232, v233, s[96:99], 0 offen sc1
    buffer_load_dwordx4 v[104:107], v1, s[24:27], s32 offen offset:0 nt
    buffer_load_dwordx4 v[108:111], v1, s[24:27], s32 offen offset:256 nt
    s_cmp_lg_u32 s86, 1
    s_cbranch_scc1 L_nd58
    ds_write_b128 v4, v[40:43] offset:0
    ds_write_b128 v4, v[44:47] offset:1024
    ds_write_b128 v4, v[48:51] offset:2048
    ds_write_b128 v4, v[52:55] offset:3072
L_nd58:
    s_waitcnt vmcnt(35)
    v_perm_b32 v9, v116, v112, s35
    v_perm_b32 v13, v116, v112, s36
    v_perm_b32 v17, v117, v113, s35
    v_perm_b32 v21, v117, v113, s36
    v_perm_b32 v25, v118, v114, s35
    v_perm_b32 v29, v118, v114, s36
    v_perm_b32 v33, v119, v115, s35
    v_perm_b32 v37, v119, v115, s36
    buffer_load_dwordx4 v[112:115], v1, s[24:27], s32 offen offset:512 nt
    buffer_load_dwordx4 v[116:119], v1, s[24:27], s32 offen offset:768 nt
    s_cmp_lg_u32 s86, 1
    s_cbranch_scc1 L_nd59
    ds_write_b128 v4, v[56:59] offset:4096
    ds_write_b128 v4, v[60:63] offset:5120
    ds_write_b128 v4, v[64:67] offset:6144
    ds_write_b128 v4, v[68:71] offset:7168
    v_mov_b64 v[40:41], 0
    v_mov_b64 v[42:43], 0
    v_mov_b64 v[44:45], 0
    v_mov_b64 v[46:47], 0
    v_mov_b64 v[48:49], 0
    v_mov_b64 v[50:51], 0
    v_mov_b64 v[52:53], 0
    v_mov_b64 v[54:55], 0
L_nd59:
    s_waitcnt vmcnt(35)
    v_perm_b32 v10, v124, v120, s35
    v_perm_b32 v14, v124, v120, s36
    v_perm_b32 v18, v125, v121, s35
    v_perm_b32 v22, v125, v121, s36
    v_perm_b32 v26, v126, v122, s35
    v_perm_b32 v30, v126, v122, s36
    v_perm_b32 v34, v127, v123, s35
    v_perm_b32 v38, v127, v123, s36
    buffer_load_dwordx4 v[120:123], v1, s[24:27], s32 offen offset:1024 nt
    buffer_load_dwordx4 v[124:127], v1, s[24:27], s32 offen offset:1280 nt
    s_cmp_lg_u32 s86, 1
    s_cbranch_scc1 L_nd60
    v_mov_b64 v[56:57], 0
    v_mov_b64 v[58:59], 0
    v_mov_b64 v[60:61], 0
    v_mov_b64 v[62:63], 0
    v_mov_b64 v[64:65], 0
    v_mov_b64 v[66:67], 0
    v_mov_b64 v[68:69], 0
    v_mov_b64 v[70:71], 0
L_nd60:
    s_waitcnt vmcnt(35)
    v_perm_b32 v11, v132, v128, s35
    v_perm_b32 v15, v132, v128, s36
    v_perm_b32 v19, v133, v129, s35
    v_mfma_f32_16x16x32_bf16 v[40:43], v[72:75], v[8:11], v[40:43]
    v_perm_b32 v23, v133, v129, s36
    v_perm_b32 v27, v134, v130, s35
    v_mfma_f32_16x16x32_bf16 v[44:47], v[72:75], v[12:15], v[44:47]
    v_perm_b32 v31, v134, v130, s36
    v_perm_b32 v35, v135, v131, s35
    v_mfma_f32_16x16x32_bf16 v[48:51], v[72:75], v[16:19], v[48:51]
    v_perm_b32 v39, v135, v131, s36
    buffer_load_dwordx4 v[128:131], v1, s[24:27], s32 offen offset:1536 nt
    v_mfma_f32_16x16x32_bf16 v[52:55], v[72:75], v[20:23], v[52:55]
    buffer_load_dwordx4 v[132:135], v1, s[24:27], s32 offen offset:1792 nt
    s_waitcnt vmcnt(35)
    v_mfma_f32_16x16x32_bf16 v[56:59], v[72:75], v[24:27], v[56:59]
    v_perm_b32 v8, v140, v136, s35
    v_perm_b32 v12, v140, v136, s36
    v_mfma_f32_16x16x32_bf16 v[60:63], v[72:75], v[28:31], v[60:63]
    v_perm_b32 v16, v141, v137, s35
    v_perm_b32 v20, v141, v137, s36
    v_mfma_f32_16x16x32_bf16 v[64:67], v[72:75], v[32:35], v[64:67]
    v_perm_b32 v24, v142, v138, s35
    v_perm_b32 v28, v142, v138, s36
    v_mfma_f32_16x16x32_bf16 v[68:71], v[72:75], v[36:39], v[68:71]
    v_perm_b32 v32, v143, v139, s35
    v_perm_b32 v36, v143, v139, s36
    buffer_load_dwordx4 v[136:139], v1, s[24:27], s32 offen offset:2048 nt
    buffer_load_dwordx4 v[140:143], v1, s[24:27], s32 offen offset:2304 nt
    s_waitcnt vmcnt(35)
    v_perm_b32 v9, v148, v144, s35
    v_perm_b32 v13, v148, v144, s36
    v_perm_b32 v17, v149, v145, s35
    v_perm_b32 v21, v149, v145, s36
    v_perm_b32 v25, v150, v146, s35
    v_perm_b32 v29, v150, v146, s36
    v_perm_b32 v33, v151, v147, s35
    v_perm_b32 v37, v151, v147, s36
    buffer_load_dwordx4 v[144:147], v1, s[24:27], s32 offen offset:2560 nt
    buffer_load_dwordx4 v[148:151], v1, s[24:27], s32 offen offset:2816 nt
    s_waitcnt vmcnt(35)
    v_perm_b32 v10, v156, v152, s35
    v_perm_b32 v14, v156, v152, s36
    v_perm_b32 v18, v157, v153, s35
    v_perm_b32 v22, v157, v153, s36
    v_perm_b32 v26, v158, v154, s35
    v_perm_b32 v30, v158, v154, s36
    v_perm_b32 v34, v159, v155, s35
    v_perm_b32 v38, v159, v155, s36
    buffer_load_dwordx4 v[152:155], v1, s[24:27], s32 offen offset:3072 nt
    buffer_load_dwordx4 v[156:159], v1, s[24:27], s32 offen offset:3328 nt
    s_waitcnt vmcnt(35)
    v_perm_b32 v11, v164, v160, s35
    v_perm_b32 v15, v164, v160, s36
    v_perm_b32 v19, v165, v161, s35
    v_mfma_f32_16x16x32_bf16 v[40:43], v[76:79], v[8:11], v[40:43]
    v_perm_b32 v23, v165, v161, s36
    v_perm_b32 v27, v166, v162, s35
    v_mfma_f32_16x16x32_bf16 v[44:47], v[76:79], v[12:15], v[44:47]
    v_perm_b32 v31, v166, v162, s36
    v_perm_b32 v35, v167, v163, s35
    v_mfma_f32_16x16x32_bf16 v[48:51], v[76:79], v[16:19], v[48:51]
    v_perm_b32 v39, v167, v163, s36
    buffer_load_dwordx4 v[160:163], v1, s[24:27], s32 offen offset:3584 nt
    v_mfma_f32_16x16x32_bf16 v[52:55], v[76:79], v[20:23], v[52:55]
    buffer_load_dwordx4 v[164:167], v1, s[24:27], s32 offen offset:3840 nt
    s_waitcnt vmcnt(35)
    v_mfma_f32_16x16x32_bf16 v[56:59], v[76:79], v[24:27], v[56:59]
    v_perm_b32 v8, v172, v168, s35
    v_perm_b32 v12, v172, v168, s36
    v_mfma_f32_16x16x32_bf16 v[60:63], v[76:79], v[28:31], v[60:63]
    v_perm_b32 v16, v173, v169, s35
    v_perm_b32 v20, v173, v169, s36
    v_mfma_f32_16x16x32_bf16 v[64:67], v[76:79], v[32:35], v[64:67]
    v_perm_b32 v24, v174, v170, s35
    v_perm_b32 v28, v174, v170, s36
    v_mfma_f32_16x16x32_bf16 v[68:71], v[76:79], v[36:39], v[68:71]
    v_perm_b32 v32, v175, v171, s35
    v_perm_b32 v36, v175, v171, s36
    buffer_load_dwordx4 v[168:171], v2, s[24:27], s32 offen offset:0 nt
    buffer_load_dwordx4 v[172:175], v2, s[24:27], s32 offen offset:256 nt
    s_waitcnt vmcnt(35)
    v_perm_b32 v9, v180, v176, s35
    v_perm_b32 v13, v180, v176, s36
    v_perm_b32 v17, v181, v177, s35
    v_perm_b32 v21, v181, v177, s36
    v_perm_b32 v25, v182, v178, s35
    v_perm_b32 v29, v182, v178, s36
    v_perm_b32 v33, v183, v179, s35
    v_perm_b32 v37, v183, v179, s36
    buffer_load_dwordx4 v[176:179], v2, s[24:27], s32 offen offset:512 nt
    buffer_load_dwordx4 v[180:183], v2, s[24:27], s32 offen offset:768 nt
    s_waitcnt vmcnt(35)
    v_perm_b32 v10, v188, v184, s35
    v_perm_b32 v14, v188, v184, s36
    v_perm_b32 v18, v189, v185, s35
    v_perm_b32 v22, v189, v185, s36
    v_perm_b32 v26, v190, v186, s35
    v_perm_b32 v30, v190, v186, s36
    v_perm_b32 v34, v191, v187, s35
    v_perm_b32 v38, v191, v187, s36
    buffer_load_dwordx4 v[184:187], v2, s[24:27], s32 offen offset:1024 nt
    buffer_load_dwordx4 v[188:191], v2, s[24:27], s32 offen offset:1280 nt
    s_waitcnt vmcnt(35)
    v_perm_b32 v11, v196, v192, s35
    v_perm_b32 v15, v196, v192, s36
    v_perm_b32 v19, v197, v193, s35
    v_mfma_f32_16x16x32_bf16 v[40:43], v[80:83], v[8:11], v[40:43]
    v_perm_b32 v23, v197, v193, s36
    v_perm_b32 v27, v198, v194, s35
    v_mfma_f32_16x16x32_bf16 v[44:47], v[80:83], v[12:15], v[44:47]
    v_perm_b32 v31, v198, v194, s36
    v_perm_b32 v35, v199, v195, s35
    v_mfma_f32_16x16x32_bf16 v[48:51], v[80:83], v[16:19], v[48:51]
    v_perm_b32 v39, v199, v195, s36
    buffer_load_dwordx4 v[192:195], v2, s[24:27], s32 offen offset:1536 nt
    v_mfma_f32_16x16x32_bf16 v[52:55], v[80:83], v[20:23], v[52:55]
    buffer_load_dwordx4 v[196:199], v2, s[24:27], s32 offen offset:1792 nt
    s_waitcnt vmcnt(35)
    v_mfma_f32_16x16x32_bf16 v[56:59], v[80:83], v[24:27], v[56:59]
    v_perm_b32 v8, v204, v200, s35
    v_perm_b32 v12, v204, v200, s36
    v_mfma_f32_16x16x32_bf16 v[60:63], v[80:83], v[28:31], v[60:63]
    v_perm_b32 v16, v205, v201, s35
    v_perm_b32 v20, v205, v201, s36
    v_mfma_f32_16x16x32_bf16 v[64:67], v[80:83], v[32:35], v[64:67]
    v_perm_b32 v24, v206, v202, s35
    v_perm_b32 v28, v206, v202, s36
    v_mfma_f32_16x16x32_bf16 v[68:71], v[80:83], v[36:39], v[68:71]
    v_perm_b32 v32, v207, v203, s35
    v_perm_b32 v36, v207, v203, s36
    buffer_load_dwordx4 v[200:203], v2, s[24:27], s32 offen offset:2048 nt
    buffer_load_dwordx4 v[204:207], v2, s[24:27], s32 offen offset:2304 nt
    s_waitcnt vmcnt(35)
    v_perm_b32 v9, v212, v208, s35
    v_perm_b32 v13, v212, v208, s36
    v_perm_b32 v17, v213, v209, s35
    v_perm_b32 v21, v213, v209, s36
    v_perm_b32 v25, v214, v210, s35
    v_perm_b32 v29, v214, v210, s36
    v_perm_b32 v33, v215, v211, s35
    v_perm_b32 v37, v215, v211, s36
    buffer_load_dwordx4 v[208:211], v2, s[24:27], s32 offen offset:2560 nt
    buffer_load_dwordx4 v[212:215], v2, s[24:27], s32 offen offset:2816 nt
    s_waitcnt vmcnt(35)
    v_perm_b32 v10, v220, v216, s35
    v_perm_b32 v14, v220, v216, s36
    v_perm_b32 v18, v221, v217, s35
    v_perm_b32 v22, v221, v217, s36
    v_perm_b32 v26, v222, v218, s35
    v_perm_b32 v30, v222, v218, s36
    v_perm_b32 v34, v223, v219, s35
    v_perm_b32 v38, v223, v219, s36
    buffer_load_dwordx4 v[216:219], v2, s[24:27], s32 offen offset:3072 nt
    buffer_load_dwordx4 v[220:223], v2, s[24:27], s32 offen offset:3328 nt
    s_waitcnt vmcnt(30)
    v_perm_b32 v11, v228, v224, s35
    v_perm_b32 v15, v228, v224, s36
    v_perm_b32 v19, v229, v225, s35
    v_mfma_f32_16x16x32_bf16 v[40:43], v[84:87], v[8:11], v[40:43]
    v_perm_b32 v23, v229, v225, s36
    v_perm_b32 v27, v230, v226, s35
    v_mfma_f32_16x16x32_bf16 v[44:47], v[84:87], v[12:15], v[44:47]
    v_perm_b32 v31, v230, v226, s36
    v_perm_b32 v35, v231, v227, s35
    v_mfma_f32_16x16x32_bf16 v[48:51], v[84:87], v[16:19], v[48:51]
    v_perm_b32 v39, v231, v227, s36
    buffer_load_dwordx4 v[224:227], v2, s[24:27], s32 offen offset:3584 nt
    v_mfma_f32_16x16x32_bf16 v[52:55], v[84:87], v[20:23], v[52:55]
    buffer_load_dwordx4 v[228:231], v2, s[24:27], s32 offen offset:3840 nt
    s_barrier
    ds_read_b64 v[4:5], v6 offset:17408
    s_waitcnt vmcnt(30)
    v_mfma_f32_16x16x32_bf16 v[56:59], v[84:87], v[24:27], v[56:59]
    v_perm_b32 v8, v108, v104, s35
    v_perm_b32 v12, v108, v104, s36
    v_mfma_f32_16x16x32_bf16 v[60:63], v[84:87], v[28:31], v[60:63]
    v_perm_b32 v16, v109, v105, s35
    v_perm_b32 v20, v109, v105, s36
    v_mfma_f32_16x16x32_bf16 v[64:67], v[84:87], v[32:35], v[64:67]
    v_perm_b32 v24, v110, v106, s35
    v_perm_b32 v28, v110, v106, s36
    v_mfma_f32_16x16x32_bf16 v[68:71], v[84:87], v[36:39], v[68:71]
    v_perm_b32 v32, v111, v107, s35
    v_perm_b32 v36, v111, v107, s36
    s_waitcnt vmcnt(28)
    v_perm_b32 v9, v116, v112, s35
    v_perm_b32 v13, v116, v112, s36
    v_perm_b32 v17, v117, v113, s35
    v_perm_b32 v21, v117, v113, s36
    v_perm_b32 v25, v118, v114, s35
    v_perm_b32 v29, v118, v114, s36
    v_perm_b32 v33, v119, v115, s35
    v_perm_b32 v37, v119, v115, s36
    s_waitcnt vmcnt(26)
    v_perm_b32 v10, v124, v120, s35
    v_perm_b32 v14, v124, v120, s36
    v_perm_b32 v18, v125, v121, s35
    v_perm_b32 v22, v125, v121, s36
    v_perm_b32 v26, v126, v122, s35
    v_perm_b32 v30, v126, v122, s36
    v_perm_b32 v34, v127, v123, s35
    v_perm_b32 v38, v127, v123, s36
    s_waitcnt vmcnt(24)
    v_perm_b32 v11, v132, v128, s35
    v_perm_b32 v15, v132, v128, s36
    v_perm_b32 v19, v133, v129, s35
    v_mfma_f32_16x16x32_bf16 v[40:43], v[88:91], v[8:11], v[40:43]
    v_perm_b32 v23, v133, v129, s36
    v_perm_b32 v27, v134, v130, s35
    v_mfma_f32_16x16x32_bf16 v[44:47], v[88:91], v[12:15], v[44:47]
    v_perm_b32 v31, v134, v130, s36
    v_perm_b32 v35, v135, v131, s35
    v_mfma_f32_16x16x32_bf16 v[48:51], v[88:91], v[16:19], v[48:51]
    v_perm_b32 v39, v135, v131, s36
    v_mfma_f32_16x16x32_bf16 v[52:55], v[88:91], v[20:23], v[52:55]
    s_waitcnt vmcnt(22)
    v_mfma_f32_16x16x32_bf16 v[56:59], v[88:91], v[24:27], v[56:59]
    v_perm_b32 v8, v140, v136, s35
    v_perm_b32 v12, v140, v136, s36
    v_mfma_f32_16x16x32_bf16 v[60:63], v[88:91], v[28:31], v[60:63]
    v_perm_b32 v16, v141, v137, s35
    v_perm_b32 v20, v141, v137, s36
    v_mfma_f32_16x16x32_bf16 v[64:67], v[88:91], v[32:35], v[64:67]
    v_perm_b32 v24, v142, v138, s35
    v_perm_b32 v28, v142, v138, s36
    v_mfma_f32_16x16x32_bf16 v[68:71], v[88:91], v[36:39], v[68:71]
    v_perm_b32 v32, v143, v139, s35
    v_perm_b32 v36, v143, v139, s36
    s_waitcnt vmcnt(20)
    v_perm_b32 v9, v148, v144, s35
    v_perm_b32 v13, v148, v144, s36
    v_perm_b32 v17, v149, v145, s35
    v_perm_b32 v21, v149, v145, s36
    v_perm_b32 v25, v150, v146, s35
    v_perm_b32 v29, v150, v146, s36
    v_perm_b32 v33, v151, v147, s35
    v_perm_b32 v37, v151, v147, s36
    s_waitcnt vmcnt(18)
    v_perm_b32 v10, v156, v152, s35
    v_perm_b32 v14, v156, v152, s36
    v_perm_b32 v18, v157, v153, s35
    v_perm_b32 v22, v157, v153, s36
    v_perm_b32 v26, v158, v154, s35
    v_perm_b32 v30, v158, v154, s36
    v_perm_b32 v34, v159, v155, s35
    v_perm_b32 v38, v159, v155, s36
    s_waitcnt vmcnt(16)
    v_perm_b32 v11, v164, v160, s35
    v_perm_b32 v15, v164, v160, s36
    v_perm_b32 v19, v165, v161, s35
    v_mfma_f32_16x16x32_bf16 v[40:43], v[92:95], v[8:11], v[40:43]
    v_perm_b32 v23, v165, v161, s36
    v_perm_b32 v27, v166, v162, s35
    v_mfma_f32_16x16x32_bf16 v[44:47], v[92:95], v[12:15], v[44:47]
    v_perm_b32 v31, v166, v162, s36
    v_perm_b32 v35, v167, v163, s35
    v_mfma_f32_16x16x32_bf16 v[48:51], v[92:95], v[16:19], v[48:51]
    v_perm_b32 v39, v167, v163, s36
    v_mfma_f32_16x16x32_bf16 v[52:55], v[92:95], v[20:23], v[52:55]
    s_waitcnt vmcnt(14)
    v_mfma_f32_16x16x32_bf16 v[56:59], v[92:95], v[24:27], v[56:59]
    v_perm_b32 v8, v172, v168, s35
    v_perm_b32 v12, v172, v168, s36
    v_mfma_f32_16x16x32_bf16 v[60:63], v[92:95], v[28:31], v[60:63]
    v_perm_b32 v16, v173, v169, s35
    v_perm_b32 v20, v173, v169, s36
    v_mfma_f32_16x16x32_bf16 v[64:67], v[92:95], v[32:35], v[64:67]
    v_perm_b32 v24, v174, v170, s35
    v_perm_b32 v28, v174, v170, s36
    v_mfma_f32_16x16x32_bf16 v[68:71], v[92:95], v[36:39], v[68:71]
    v_perm_b32 v32, v175, v171, s35
    v_perm_b32 v36, v175, v171, s36
    s_waitcnt vmcnt(12)
    v_perm_b32 v9, v180, v176, s35
    v_perm_b32 v13, v180, v176, s36
    v_perm_b32 v17, v181, v177, s35
    v_perm_b32 v21, v181, v177, s36
    v_perm_b32 v25, v182, v178, s35
    v_perm_b32 v29, v182, v178, s36
    v_perm_b32 v33, v183, v179, s35
    v_perm_b32 v37, v183, v179, s36
    s_waitcnt vmcnt(10)
    v_perm_b32 v10, v188, v184, s35
    v_perm_b32 v14, v188, v184, s36
    v_perm_b32 v18, v189, v185, s35
    v_perm_b32 v22, v189, v185, s36
    v_perm_b32 v26, v190, v186, s35
    v_perm_b32 v30, v190, v186, s36
    v_perm_b32 v34, v191, v187, s35
    v_perm_b32 v38, v191, v187, s36
    s_waitcnt vmcnt(8)
    v_perm_b32 v11, v196, v192, s35
    v_perm_b32 v15, v196, v192, s36
    v_perm_b32 v19, v197, v193, s35
    v_mfma_f32_16x16x32_bf16 v[40:43], v[96:99], v[8:11], v[40:43]
    v_perm_b32 v23, v197, v193, s36
    v_perm_b32 v27, v198, v194, s35
    v_mfma_f32_16x16x32_bf16 v[44:47], v[96:99], v[12:15], v[44:47]
    v_perm_b32 v31, v198, v194, s36
    v_perm_b32 v35, v199, v195, s35
    v_mfma_f32_16x16x32_bf16 v[48:51], v[96:99], v[16:19], v[48:51]
    v_perm_b32 v39, v199, v195, s36
    v_mfma_f32_16x16x32_bf16 v[52:55], v[96:99], v[20:23], v[52:55]
    s_waitcnt vmcnt(6)
    v_mfma_f32_16x16x32_bf16 v[56:59], v[96:99], v[24:27], v[56:59]
    v_perm_b32 v8, v204, v200, s35
    v_perm_b32 v12, v204, v200, s36
    v_mfma_f32_16x16x32_bf16 v[60:63], v[96:99], v[28:31], v[60:63]
    v_perm_b32 v16, v205, v201, s35
    v_perm_b32 v20, v205, v201, s36
    v_mfma_f32_16x16x32_bf16 v[64:67], v[96:99], v[32:35], v[64:67]
    v_perm_b32 v24, v206, v202, s35
    v_perm_b32 v28, v206, v202, s36
    v_mfma_f32_16x16x32_bf16 v[68:71], v[96:99], v[36:39], v[68:71]
    v_perm_b32 v32, v207, v203, s35
    v_perm_b32 v36, v207, v203, s36
    s_waitcnt vmcnt(4)
    v_perm_b32 v9, v212, v208, s35
    v_perm_b32 v13, v212, v208, s36
    v_perm_b32 v17, v213, v209, s35
    v_perm_b32 v21, v213, v209, s36
    v_perm_b32 v25, v214, v210, s35
    v_perm_b32 v29, v214, v210, s36
    v_perm_b32 v33, v215, v211, s35
    v_perm_b32 v37, v215, v211, s36
    s_waitcnt vmcnt(2)
    v_perm_b32 v10, v220, v216, s35
    v_perm_b32 v14, v220, v216, s36
    v_perm_b32 v18, v221, v217, s35
    v_perm_b32 v22, v221, v217, s36
    v_perm_b32 v26, v222, v218, s35
    v_perm_b32 v30, v222, v218, s36
    v_perm_b32 v34, v223, v219, s35
    v_perm_b32 v38, v223, v219, s36
    s_waitcnt vmcnt(0)
    v_perm_b32 v11, v228, v224, s35
    v_perm_b32 v15, v228, v224, s36
    v_perm_b32 v19, v229, v225, s35
    v_mfma_f32_16x16x32_bf16 v[40:43], v[100:103], v[8:11], v[40:43]
    v_perm_b32 v23, v229, v225, s36
    v_perm_b32 v27, v230, v226, s35
    v_mfma_f32_16x16x32_bf16 v[44:47], v[100:103], v[12:15], v[44:47]
    v_perm_b32 v31, v230, v226, s36
    v_perm_b32 v35, v231, v227, s35
    v_mfma_f32_16x16x32_bf16 v[48:51], v[100:103], v[16:19], v[48:51]
    v_perm_b32 v39, v231, v227, s36
    v_mfma_f32_16x16x32_bf16 v[52:55], v[100:103], v[20:23], v[52:55]
    s_waitcnt lgkmcnt(0)
    v_mfma_f32_16x16x32_bf16 v[56:59], v[100:103], v[24:27], v[56:59]
    v_cvt_pk_bf16_f32 v8, v40, v41
    v_cvt_pk_bf16_f32 v9, v42, v43
    v_mfma_f32_16x16x32_bf16 v[60:63], v[100:103], v[28:31], v[60:63]
    v_cvt_pk_bf16_f32 v10, v44, v45
    v_cvt_pk_bf16_f32 v11, v46, v47
    v_mfma_f32_16x16x32_bf16 v[64:67], v[100:103], v[32:35], v[64:67]
    v_cvt_pk_bf16_f32 v12, v48, v49
    v_cvt_pk_bf16_f32 v13, v50, v51
    v_mfma_f32_16x16x32_bf16 v[68:71], v[100:103], v[36:39], v[68:71]
    v_cvt_pk_bf16_f32 v14, v52, v53
    v_cvt_pk_bf16_f32 v15, v54, v55
    v_mfma_f32_16x16x16_bf16 v[40:43], v[4:5], v[8:9], 0
    v_cvt_pk_bf16_f32 v16, v56, v57
    v_cvt_pk_bf16_f32 v17, v58, v59
    v_mfma_f32_16x16x16_bf16 v[44:47], v[4:5], v[10:11], 0
    v_cvt_pk_bf16_f32 v18, v60, v61
    v_cvt_pk_bf16_f32 v19, v62, v63
    v_mfma_f32_16x16x16_bf16 v[48:51], v[4:5], v[12:13], 0
    v_cvt_pk_bf16_f32 v20, v64, v65
    v_cvt_pk_bf16_f32 v21, v66, v67
    v_mfma_f32_16x16x16_bf16 v[52:55], v[4:5], v[14:15], 0
    v_cvt_pk_bf16_f32 v22, v68, v69
    v_cvt_pk_bf16_f32 v23, v70, v71
    v_mfma_f32_16x16x16_bf16 v[56:59], v[4:5], v[16:17], 0
    v_mfma_f32_16x16x16_bf16 v[60:63], v[4:5], v[18:19], 0
    v_mfma_f32_16x16x16_bf16 v[64:67], v[4:5], v[20:21], 0
    v_mfma_f32_16x16x16_bf16 v[68:71], v[4:5], v[22:23], 0
    v_cvt_pk_bf16_f32 v24, v40, v44
    s_nop 0
    v_cvt_pk_bf16_f32 v25, v48, v52
    s_nop 2
    v_cvt_pk_bf16_f32 v26, v56, v60
    s_nop 0
    v_cvt_pk_bf16_f32 v27, v64, v68
    buffer_store_dwordx4 v[24:27], v6, s[44:47], 0 offen
    s_endpgm
    .p2align 3
L_v5:
    s_add_u32 s34, s34, 1
    s_and_b32 s34, s34, 31
    s_and_b32 s3, s34, 3
    s_lshl_b32 s3, s3, 14
    s_lshr_b32 s32, s34, 2
    s_lshl_b32 s32, s32, 17
    s_or_b32 s32, s32, s3
    s_lshr_b32 s33, s32, 7
    s_add_u32 s39, s39, 1
    s_cmp_lg_u32 s39, 32
    s_cbranch_scc1 L_adv61
    s_add_u32 s24, s24, 2097152
    s_addc_u32 s25, s25, 0
    s_cmp_eq_u32 s51, 1
    s_cselect_b64 s[24:25], s[28:29], s[24:25]
    s_cselect_b64 s[20:21], s[12:13], s[20:21]
    s_mov_b32 s39, 0
    s_add_u32 s51, s51, 1
    s_cmp_ge_u32 s51, 4
    s_cselect_b32 s26, 0, s26
    s_cselect_b32 s22, 0, s22
L_adv61:
    s_waitcnt vmcnt(30)
    v_perm_b32 v8, v108, v104, s35
    v_perm_b32 v12, v108, v104, s36
    v_perm_b32 v16, v109, v105, s35
    v_perm_b32 v20, v109, v105, s36
    v_perm_b32 v24, v110, v106, s35
    v_perm_b32 v28, v110, v106, s36
    v_perm_b32 v32, v111, v107, s35
    v_perm_b32 v36, v111, v107, s36
    s_waitcnt vmcnt(19)
    buffer_load_dwordx4 v[88:91], v3, s[20:23], s33 offen offset:0
    buffer_load_dwordx4 v[92:95], v3, s[20:23], s33 offen offset:16
    buffer_load_dwordx4 v[96:99], v3, s[20:23], s33 offen offset:32
    buffer_load_dwordx4 v[100:103], v3, s[20:23], s33 offen offset:48
    buffer_load_dword v232, v233, s[96:99], 0 offen sc1
    buffer_load_dwordx4 v[104:107], v1, s[24:27], s32 offen offset:0 nt
    buffer_load_dwordx4 v[108:111], v1, s[24:27], s32 offen offset:256 nt
    s_cmp_lg_u32 s86, 1
    s_cbranch_scc1 L_nd62
    ds_write_b128 v4, v[40:43] offset:0
    ds_write_b128 v4, v[44:47] offset:1024
    ds_write_b128 v4, v[48:51] offset:2048
    ds_write_b128 v4, v[52:55] offset:3072
L_nd62:
    v_perm_b32 v9, v116, v112, s35
    v_perm_b32 v13, v116, v112, s36
    v_perm_b32 v17, v117, v113, s35
    v_perm_b32 v21, v117, v113, s36
    v_perm_b32 v25, v118, v114, s35
    v_perm_b32 v29, v118, v114, s36
    v_perm_b32 v33, v119, v115, s35
    v_perm_b32 v37, v119, v115, s36
    s_waitcnt vmcnt(24)
    buffer_load_dwordx4 v[112:115], v1, s[24:27], s32 offen offset:512 nt
    buffer_load_dwordx4 v[116:119], v1, s[24:27], s32 offen offset:768 nt
    s_cmp_lg_u32 s86, 1
    s_cbranch_scc1 L_nd63
    ds_write_b128 v4, v[56:59] offset:4096
    ds_write_b128 v4, v[60:63] offset:5120
    ds_write_b128 v4, v[64:67] offset:6144
    ds_write_b128 v4, v[68:71] offset:7168
    v_mov_b64 v[40:41], 0
    v_mov_b64 v[42:43], 0
    v_mov_b64 v[44:45], 0
    v_mov_b64 v[46:47], 0
    v_mov_b64 v[48:49], 0
    v_mov_b64 v[50:51], 0
    v_mov_b64 v[52:53], 0
    v_mov_b64 v[54:55], 0
L_nd63:
    v_perm_b32 v10, v124, v120, s35
    v_perm_b32 v14, v124, v120, s36
    v_perm_b32 v18, v125, v121, s35
    v_perm_b32 v22, v125, v121, s36
    v_perm_b32 v26, v126, v122, s35
    v_perm_b32 v30, v126, v122, s36
    v_perm_b32 v34, v127, v123, s35
    v_perm_b32 v38, v127, v123, s36
    s_waitcnt vmcnt(24)
    buffer_load_dwordx4 v[120:123], v1, s[24:27], s32 offen offset:1024 nt
    buffer_load_dwordx4 v[124:127], v1, s[24:27], s32 offen offset:1280 nt
    s_cmp_lg_u32 s86, 1
    s_cbranch_scc1 L_nd64
    v_mov_b64 v[56:57], 0
    v_mov_b64 v[58:59], 0
    v_mov_b64 v[60:61], 0
    v_mov_b64 v[62:63], 0
    v_mov_b64 v[64:65], 0
    v_mov_b64 v[66:67], 0
    v_mov_b64 v[68:69], 0
    v_mov_b64 v[70:71], 0
L_nd64:
    v_perm_b32 v11, v132, v128, s35
    v_perm_b32 v15, v132, v128, s36
    v_perm_b32 v19, v133, v129, s35
    v_mfma_f32_16x16x32_bf16 v[40:43], v[72:75], v[8:11], v[40:43]
    v_perm_b32 v23, v133, v129, s36
    v_perm_b32 v27, v134, v130, s35
    v_mfma_f32_16x16x32_bf16 v[44:47], v[72:75], v[12:15], v[44:47]
    v_perm_b32 v31, v134, v130, s36
    v_perm_b32 v35, v135, v131, s35
    v_mfma_f32_16x16x32_bf16 v[48:51], v[72:75], v[16:19], v[48:51]
    v_perm_b32 v39, v135, v131, s36
    v_mfma_f32_16x16x32_bf16 v[52:55], v[72:75], v[20:23], v[52:55]
    s_waitcnt vmcnt(24)
    buffer_load_dwordx4 v[128:131], v1, s[24:27], s32 offen offset:1536 nt
    buffer_load_dwordx4 v[132:135], v1, s[24:27], s32 offen offset:1792 nt
    v_mfma_f32_16x16x32_bf16 v[56:59], v[72:75], v[24:27], v[56:59]
    v_perm_b32 v8, v140, v136, s35
    v_perm_b32 v12, v140, v136, s36
    v_mfma_f32_16x16x32_bf16 v[60:63], v[72:75], v[28:31], v[60:63]
    v_perm_b32 v16, v141, v137, s35
    v_perm_b32 v20, v141, v137, s36
    v_mfma_f32_16x16x32_bf16 v[64:67], v[72:75], v[32:35], v[64:67]
    v_perm_b32 v24, v142, v138, s35
    v_perm_b32 v28, v142, v138, s36
    v_mfma_f32_16x16x32_bf16 v[68:71], v[72:75], v[36:39], v[68:71]
    v_perm_b32 v32, v143, v139, s35
    v_perm_b32 v36, v143, v139, s36
    s_waitcnt vmcnt(24)
    buffer_load_dwordx4 v[136:139], v1, s[24:27], s32 offen offset:2048 nt
    buffer_load_dwordx4 v[140:143], v1, s[24:27], s32 offen offset:2304 nt
    v_perm_b32 v9, v148, v144, s35
    v_perm_b32 v13, v148, v144, s36
    v_perm_b32 v17, v149, v145, s35
    v_perm_b32 v21, v149, v145, s36
    v_perm_b32 v25, v150, v146, s35
    v_perm_b32 v29, v150, v146, s36
    v_perm_b32 v33, v151, v147, s35
    v_perm_b32 v37, v151, v147, s36
    s_waitcnt vmcnt(24)
    buffer_load_dwordx4 v[144:147], v1, s[24:27], s32 offen offset:2560 nt
    buffer_load_dwordx4 v[148:151], v1, s[24:27], s32 offen offset:2816 nt
    v_perm_b32 v10, v156, v152, s35
    v_perm_b32 v14, v156, v152, s36
    v_perm_b32 v18, v157, v153, s35
    v_perm_b32 v22, v157, v153, s36
    v_perm_b32 v26, v158, v154, s35
    v_perm_b32 v30, v158, v154, s36
    v_perm_b32 v34, v159, v155, s35
    v_perm_b32 v38, v159, v155, s36
    s_waitcnt vmcnt(24)
    buffer_load_dwordx4 v[152:155], v1, s[24:27], s32 offen offset:3072 nt
    buffer_load_dwordx4 v[156:159], v1, s[24:27], s32 offen offset:3328 nt
    v_perm_b32 v11, v164, v160, s35
    v_perm_b32 v15, v164, v160, s36
    v_perm_b32 v19, v165, v161, s35
    v_mfma_f32_16x16x32_bf16 v[40:43], v[76:79], v[8:11], v[40:43]
    v_perm_b32 v23, v165, v161, s36
    v_perm_b32 v27, v166, v162, s35
    v_mfma_f32_16x16x32_bf16 v[44:47], v[76:79], v[12:15], v[44:47]
    v_perm_b32 v31, v166, v162, s36
    v_perm_b32 v35, v167, v163, s35
    v_mfma_f32_16x16x32_bf16 v[48:51], v[76:79], v[16:19], v[48:51]
    v_perm_b32 v39, v167, v163, s36
    v_mfma_f32_16x16x32_bf16 v[52:55], v[76:79], v[20:23], v[52:55]
    s_waitcnt vmcnt(24)
    buffer_load_dwordx4 v[160:163], v1, s[24:27], s32 offen offset:3584 nt
    buffer_load_dwordx4 v[164:167], v1, s[24:27], s32 offen offset:3840 nt
    v_mfma_f32_16x16x32_bf16 v[56:59], v[76:79], v[24:27], v[56:59]
    v_perm_b32 v8, v172, v168, s35
    v_perm_b32 v12, v172, v168, s36
    v_mfma_f32_16x16x32_bf16 v[60:63], v[76:79], v[28:31], v[60:63]
    v_perm_b32 v16, v173, v169, s35
    v_perm_b32 v20, v173, v169, s36
    v_mfma_f32_16x16x32_bf16 v[64:67], v[76:79], v[32:35], v[64:67]
    v_perm_b32 v24, v174, v170, s35
    v_perm_b32 v28, v174, v170, s36
    v_mfma_f32_16x16x32_bf16 v[68:71], v[76:79], v[36:39], v[68:71]
    v_perm_b32 v32, v175, v171, s35
    v_perm_b32 v36, v175, v171, s36
    s_waitcnt vmcnt(24)
    buffer_load_dwordx4 v[168:171], v2, s[24:27], s32 offen offset:0 nt
    buffer_load_dwordx4 v[172:175], v2, s[24:27], s32 offen offset:256 nt
    v_perm_b32 v9, v180, v176, s35
    v_perm_b32 v13, v180, v176, s36
    v_perm_b32 v17, v181, v177, s35
    v_perm_b32 v21, v181, v177, s36
    v_perm_b32 v25, v182, v178, s35
    v_perm_b32 v29, v182, v178, s36
    v_perm_b32 v33, v183, v179, s35
    v_perm_b32 v37, v183, v179, s36
    s_waitcnt vmcnt(24)
    buffer_load_dwordx4 v[176:179], v2, s[24:27], s32 offen offset:512 nt
    buffer_load_dwordx4 v[180:183], v2, s[24:27], s32 offen offset:768 nt
    v_perm_b32 v10, v188, v184, s35
    v_perm_b32 v14, v188, v184, s36
    v_perm_b32 v18, v189, v185, s35
    v_perm_b32 v22, v189, v185, s36
    v_perm_b32 v26, v190, v186, s35
    v_perm_b32 v30, v190, v186, s36
    v_perm_b32 v34, v191, v187, s35
    v_perm_b32 v38, v191, v187, s36
    s_waitcnt vmcnt(19)
    buffer_load_dwordx4 v[184:187], v2, s[24:27], s32 offen offset:1024 nt
    buffer_load_dwordx4 v[188:191], v2, s[24:27], s32 offen offset:1280 nt
    v_perm_b32 v11, v196, v192, s35
    v_perm_b32 v15, v196, v192, s36
    v_perm_b32 v19, v197, v193, s35
    v_mfma_f32_16x16x32_bf16 v[40:43], v[80:83], v[8:11], v[40:43]
    v_perm_b32 v23, v197, v193, s36
    v_perm_b32 v27, v198, v194, s35
    v_mfma_f32_16x16x32_bf16 v[44:47], v[80:83], v[12:15], v[44:47]
    v_perm_b32 v31, v198, v194, s36
    v_perm_b32 v35, v199, v195, s35
    v_mfma_f32_16x16x32_bf16 v[48:51], v[80:83], v[16:19], v[48:51]
    v_perm_b32 v39, v199, v195, s36
    v_mfma_f32_16x16x32_bf16 v[52:55], v[80:83], v[20:23], v[52:55]
    s_waitcnt vmcnt(19)
    buffer_load_dwordx4 v[192:195], v2, s[24:27], s32 offen offset:1536 nt
    buffer_load_dwordx4 v[196:199], v2, s[24:27], s32 offen offset:1792 nt
    v_mfma_f32_16x16x32_bf16 v[56:59], v[80:83], v[24:27], v[56:59]
    v_perm_b32 v8, v204, v200, s35
    v_perm_b32 v12, v204, v200, s36
    v_mfma_f32_16x16x32_bf16 v[60:63], v[80:83], v[28:31], v[60:63]
    v_perm_b32 v16, v205, v201, s35
    v_perm_b32 v20, v205, v201, s36
    v_mfma_f32_16x16x32_bf16 v[64:67], v[80:83], v[32:35], v[64:67]
    v_perm_b32 v24, v206, v202, s35
    v_perm_b32 v28, v206, v202, s36
    v_mfma_f32_16x16x32_bf16 v[68:71], v[80:83], v[36:39], v[68:71]
    v_perm_b32 v32, v207, v203, s35
    v_perm_b32 v36, v207, v203, s36
    s_waitcnt vmcnt(19)
    buffer_load_dwordx4 v[200:203], v2, s[24:27], s32 offen offset:2048 nt
    buffer_load_dwordx4 v[204:207], v2, s[24:27], s32 offen offset:2304 nt
    v_perm_b32 v9, v212, v208, s35
    v_perm_b32 v13, v212, v208, s36
    v_perm_b32 v17, v213, v209, s35
    v_perm_b32 v21, v213, v209, s36
    v_perm_b32 v25, v214, v210, s35
    v_perm_b32 v29, v214, v210, s36
    v_perm_b32 v33, v215, v211, s35
    v_perm_b32 v37, v215, v211, s36
    s_waitcnt vmcnt(19)
    buffer_load_dwordx4 v[208:211], v2, s[24:27], s32 offen offset:2560 nt
    buffer_load_dwordx4 v[212:215], v2, s[24:27], s32 offen offset:2816 nt
    v_perm_b32 v10, v220, v216, s35
    v_perm_b32 v14, v220, v216, s36
    v_perm_b32 v18, v221, v217, s35
    v_perm_b32 v22, v221, v217, s36
    v_perm_b32 v26, v222, v218, s35
    v_perm_b32 v30, v222, v218, s36
    v_perm_b32 v34, v223, v219, s35
    v_perm_b32 v38, v223, v219, s36
    s_waitcnt vmcnt(19)
    buffer_load_dwordx4 v[216:219], v2, s[24:27], s32 offen offset:3072 nt
    buffer_load_dwordx4 v[220:223], v2, s[24:27], s32 offen offset:3328 nt
    v_perm_b32 v11, v228, v224, s35
    v_perm_b32 v15, v228, v224, s36
    v_perm_b32 v19, v229, v225, s35
    v_mfma_f32_16x16x32_bf16 v[40:43], v[84:87], v[8:11], v[40:43]
    v_perm_b32 v23, v229, v225, s36
    v_perm_b32 v27, v230, v226, s35
    v_mfma_f32_16x16x32_bf16 v[44:47], v[84:87], v[12:15], v[44:47]
    v_perm_b32 v31, v230, v226, s36
    v_perm_b32 v35, v231, v227, s35
    v_mfma_f32_16x16x32_bf16 v[48:51], v[84:87], v[16:19], v[48:51]
    v_perm_b32 v39, v231, v227, s36
    v_mfma_f32_16x16x32_bf16 v[52:55], v[84:87], v[20:23], v[52:55]
    s_waitcnt vmcnt(19)
    buffer_load_dwordx4 v[224:227], v2, s[24:27], s32 offen offset:3584 nt
    buffer_load_dwordx4 v[228:231], v2, s[24:27], s32 offen offset:3840 nt
    s_barrier
    ds_read_b64 v[4:5], v6 offset:17408
    s_waitcnt vmcnt(30)
    v_mfma_f32_16x16x32_bf16 v[56:59], v[84:87], v[24:27], v[56:59]
    v_perm_b32 v8, v108, v104, s35
    v_perm_b32 v12, v108, v104, s36
    v_mfma_f32_16x16x32_bf16 v[60:63], v[84:87], v[28:31], v[60:63]
    v_perm_b32 v16, v109, v105, s35
    v_perm_b32 v20, v109, v105, s36
    v_mfma_f32_16x16x32_bf16 v[64:67], v[84:87], v[32:35], v[64:67]
    v_perm_b32 v24, v110, v106, s35
    v_perm_b32 v28, v110, v106, s36
    v_mfma_f32_16x16x32_bf16 v[68:71], v[84:87], v[36:39], v[68:71]
    v_perm_b32 v32, v111, v107, s35
    v_perm_b32 v36, v111, v107, s36
    s_waitcnt vmcnt(28)
    v_perm_b32 v9, v116, v112, s35
    v_perm_b32 v13, v116, v112, s36
    v_perm_b32 v17, v117, v113, s35
    v_perm_b32 v21, v117, v113, s36
    v_perm_b32 v25, v118, v114, s35
    v_perm_b32 v29, v118, v114, s36
    v_perm_b32 v33, v119, v115, s35
    v_perm_b32 v37, v119, v115, s36
    s_waitcnt vmcnt(26)
    v_perm_b32 v10, v124, v120, s35
    v_perm_b32 v14, v124, v120, s36
    v_perm_b32 v18, v125, v121, s35
    v_perm_b32 v22, v125, v121, s36
    v_perm_b32 v26, v126, v122, s35
    v_perm_b32 v30, v126, v122, s36
    v_perm_b32 v34, v127, v123, s35
    v_perm_b32 v38, v127, v123, s36
    s_waitcnt vmcnt(24)
    v_perm_b32 v11, v132, v128, s35
    v_perm_b32 v15, v132, v128, s36
    v_perm_b32 v19, v133, v129, s35
    v_mfma_f32_16x16x32_bf16 v[40:43], v[88:91], v[8:11], v[40:43]
    v_perm_b32 v23, v133, v129, s36
    v_perm_b32 v27, v134, v130, s35
    v_mfma_f32_16x16x32_bf16 v[44:47], v[88:91], v[12:15], v[44:47]
    v_perm_b32 v31, v134, v130, s36
    v_perm_b32 v35, v135, v131, s35
    v_mfma_f32_16x16x32_bf16 v[48:51], v[88:91], v[16:19], v[48:51]
    v_perm_b32 v39, v135, v131, s36
    v_mfma_f32_16x16x32_bf16 v[52:55], v[88:91], v[20:23], v[52:55]
    s_waitcnt vmcnt(22)
    v_mfma_f32_16x16x32_bf16 v[56:59], v[88:91], v[24:27], v[56:59]
    v_perm_b32 v8, v140, v136, s35
    v_perm_b32 v12, v140, v136, s36
    v_mfma_f32_16x16x32_bf16 v[60:63], v[88:91], v[28:31], v[60:63]
    v_perm_b32 v16, v141, v137, s35
    v_perm_b32 v20, v141, v137, s36
    v_mfma_f32_16x16x32_bf16 v[64:67], v[88:91], v[32:35], v[64:67]
    v_perm_b32 v24, v142, v138, s35
    v_perm_b32 v28, v142, v138, s36
    v_mfma_f32_16x16x32_bf16 v[68:71], v[88:91], v[36:39], v[68:71]
    v_perm_b32 v32, v143, v139, s35
    v_perm_b32 v36, v143, v139, s36
    s_waitcnt vmcnt(20)
    v_perm_b32 v9, v148, v144, s35
    v_perm_b32 v13, v148, v144, s36
    v_perm_b32 v17, v149, v145, s35
    v_perm_b32 v21, v149, v145, s36
    v_perm_b32 v25, v150, v146, s35
    v_perm_b32 v29, v150, v146, s36
    v_perm_b32 v33, v151, v147, s35
    v_perm_b32 v37, v151, v147, s36
    s_waitcnt vmcnt(18)
    v_perm_b32 v10, v156, v152, s35
    v_perm_b32 v14, v156, v152, s36
    v_perm_b32 v18, v157, v153, s35
    v_perm_b32 v22, v157, v153, s36
    v_perm_b32 v26, v158, v154, s35
    v_perm_b32 v30, v158, v154, s36
    v_perm_b32 v34, v159, v155, s35
    v_perm_b32 v38, v159, v155, s36
    s_waitcnt vmcnt(16)
    v_perm_b32 v11, v164, v160, s35
    v_perm_b32 v15, v164, v160, s36
    v_perm_b32 v19, v165, v161, s35
    v_mfma_f32_16x16x32_bf16 v[40:43], v[92:95], v[8:11], v[40:43]
    v_perm_b32 v23, v165, v161, s36
    v_perm_b32 v27, v166, v162, s35
    v_mfma_f32_16x16x32_bf16 v[44:47], v[92:95], v[12:15], v[44:47]
    v_perm_b32 v31, v166, v162, s36
    v_perm_b32 v35, v167, v163, s35
    v_mfma_f32_16x16x32_bf16 v[48:51], v[92:95], v[16:19], v[48:51]
    v_perm_b32 v39, v167, v163, s36
    v_mfma_f32_16x16x32_bf16 v[52:55], v[92:95], v[20:23], v[52:55]
    s_waitcnt vmcnt(14)
    v_mfma_f32_16x16x32_bf16 v[56:59], v[92:95], v[24:27], v[56:59]
    v_perm_b32 v8, v172, v168, s35
    v_perm_b32 v12, v172, v168, s36
    v_mfma_f32_16x16x32_bf16 v[60:63], v[92:95], v[28:31], v[60:63]
    v_perm_b32 v16, v173, v169, s35
    v_perm_b32 v20, v173, v169, s36
    v_mfma_f32_16x16x32_bf16 v[64:67], v[92:95], v[32:35], v[64:67]
    v_perm_b32 v24, v174, v170, s35
    v_perm_b32 v28, v174, v170, s36
    v_mfma_f32_16x16x32_bf16 v[68:71], v[92:95], v[36:39], v[68:71]
    v_perm_b32 v32, v175, v171, s35
    v_perm_b32 v36, v175, v171, s36
    s_waitcnt vmcnt(12)
    v_perm_b32 v9, v180, v176, s35
    v_perm_b32 v13, v180, v176, s36
    v_perm_b32 v17, v181, v177, s35
    v_perm_b32 v21, v181, v177, s36
    v_perm_b32 v25, v182, v178, s35
    v_perm_b32 v29, v182, v178, s36
    v_perm_b32 v33, v183, v179, s35
    v_perm_b32 v37, v183, v179, s36
    s_waitcnt vmcnt(10)
    v_perm_b32 v10, v188, v184, s35
    v_perm_b32 v14, v188, v184, s36
    v_perm_b32 v18, v189, v185, s35
    v_perm_b32 v22, v189, v185, s36
    v_perm_b32 v26, v190, v186, s35
    v_perm_b32 v30, v190, v186, s36
    v_perm_b32 v34, v191, v187, s35
    v_perm_b32 v38, v191, v187, s36
    s_waitcnt vmcnt(8)
    v_perm_b32 v11, v196, v192, s35
    v_perm_b32 v15, v196, v192, s36
    v_perm_b32 v19, v197, v193, s35
    v_mfma_f32_16x16x32_bf16 v[40:43], v[96:99], v[8:11], v[40:43]
    v_perm_b32 v23, v197, v193, s36
    v_perm_b32 v27, v198, v194, s35
    v_mfma_f32_16x16x32_bf16 v[44:47], v[96:99], v[12:15], v[44:47]
    v_perm_b32 v31, v198, v194, s36
    v_perm_b32 v35, v199, v195, s35
    v_mfma_f32_16x16x32_bf16 v[48:51], v[96:99], v[16:19], v[48:51]
    v_perm_b32 v39, v199, v195, s36
    v_mfma_f32_16x16x32_bf16 v[52:55], v[96:99], v[20:23], v[52:55]
    s_waitcnt vmcnt(6)
    v_mfma_f32_16x16x32_bf16 v[56:59], v[96:99], v[24:27], v[56:59]
    v_perm_b32 v8, v204, v200, s35
    v_perm_b32 v12, v204, v200, s36
    v_mfma_f32_16x16x32_bf16 v[60:63], v[96:99], v[28:31], v[60:63]
    v_perm_b32 v16, v205, v201, s35
    v_perm_b32 v20, v205, v201, s36
    v_mfma_f32_16x16x32_bf16 v[64:67], v[96:99], v[32:35], v[64:67]
    v_perm_b32 v24, v206, v202, s35
    v_perm_b32 v28, v206, v202, s36
    v_mfma_f32_16x16x32_bf16 v[68:71], v[96:99], v[36:39], v[68:71]
    v_perm_b32 v32, v207, v203, s35
    v_perm_b32 v36, v207, v203, s36
    s_waitcnt vmcnt(4)
    v_perm_b32 v9, v212, v208, s35
    v_perm_b32 v13, v212, v208, s36
    v_perm_b32 v17, v213, v209, s35
    v_perm_b32 v21, v213, v209, s36
    v_perm_b32 v25, v214, v210, s35
    v_perm_b32 v29, v214, v210, s36
    v_perm_b32 v33, v215, v211, s35
    v_perm_b32 v37, v215, v211, s36
    s_waitcnt vmcnt(2)
    v_perm_b32 v10, v220, v216, s35
    v_perm_b32 v14, v220, v216, s36
    v_perm_b32 v18, v221, v217, s35
    v_perm_b32 v22, v221, v217, s36
    v_perm_b32 v26, v222, v218, s35
    v_perm_b32 v30, v222, v218, s36
    v_perm_b32 v34, v223, v219, s35
    v_perm_b32 v38, v223, v219, s36
    s_waitcnt vmcnt(0)
    v_perm_b32 v11, v228, v224, s35
    v_perm_b32 v15, v228, v224, s36
    v_perm_b32 v19, v229, v225, s35
    v_mfma_f32_16x16x32_bf16 v[40:43], v[100:103], v[8:11], v[40:43]
    v_perm_b32 v23, v229, v225, s36
    v_perm_b32 v27, v230, v226, s35
    v_mfma_f32_16x16x32_bf16 v[44:47], v[100:103], v[12:15], v[44:47]
    v_perm_b32 v31, v230, v226, s36
    v_perm_b32 v35, v231, v227, s35
    v_mfma_f32_16x16x32_bf16 v[48:51], v[100:103], v[16:19], v[48:51]
    v_perm_b32 v39, v231, v227, s36
    v_mfma_f32_16x16x32_bf16 v[52:55], v[100:103], v[20:23], v[52:55]
    s_waitcnt lgkmcnt(0)
    v_mfma_f32_16x16x32_bf16 v[56:59], v[100:103], v[24:27], v[56:59]
    v_cvt_pk_bf16_f32 v8, v40, v41
    v_cvt_pk_bf16_f32 v9, v42, v43
    v_mfma_f32_16x16x32_bf16 v[60:63], v[100:103], v[28:31], v[60:63]
    v_cvt_pk_bf16_f32 v10, v44, v45
    v_cvt_pk_bf16_f32 v11, v46, v47
    v_mfma_f32_16x16x32_bf16 v[64:67], v[100:103], v[32:35], v[64:67]
    v_cvt_pk_bf16_f32 v12, v48, v49
    v_cvt_pk_bf16_f32 v13, v50, v51
    v_mfma_f32_16x16x32_bf16 v[68:71], v[100:103], v[36:39], v[68:71]
    v_cvt_pk_bf16_f32 v14, v52, v53
    v_cvt_pk_bf16_f32 v15, v54, v55
    v_mfma_f32_16x16x16_bf16 v[40:43], v[4:5], v[8:9], 0
    v_cvt_pk_bf16_f32 v16, v56, v57
    v_cvt_pk_bf16_f32 v17, v58, v59
    v_mfma_f32_16x16x16_bf16 v[44:47], v[4:5], v[10:11], 0
    v_cvt_pk_bf16_f32 v18, v60, v61
    v_cvt_pk_bf16_f32 v19, v62, v63
    v_mfma_f32_16x16x16_bf16 v[48:51], v[4:5], v[12:13], 0
    v_cvt_pk_bf16_f32 v20, v64, v65
    v_cvt_pk_bf16_f32 v21, v66, v67
    v_mfma_f32_16x16x16_bf16 v[52:55], v[4:5], v[14:15], 0
    v_cvt_pk_bf16_f32 v22, v68, v69
    v_cvt_pk_bf16_f32 v23, v70, v71
    v_mfma_f32_16x16x16_bf16 v[56:59], v[4:5], v[16:17], 0
    v_mfma_f32_16x16x16_bf16 v[60:63], v[4:5], v[18:19], 0
    v_mfma_f32_16x16x16_bf16 v[64:67], v[4:5], v[20:21], 0
    v_mfma_f32_16x16x16_bf16 v[68:71], v[4:5], v[22:23], 0
    v_cvt_pk_bf16_f32 v24, v40, v44
    s_nop 0
    v_cvt_pk_bf16_f32 v25, v48, v52
    s_nop 2
    v_cvt_pk_bf16_f32 v26, v56, v60
    s_nop 0
    v_cvt_pk_bf16_f32 v27, v64, v68
    buffer_store_dwordx4 v[24:27], v6, s[44:47], 0 offen
    s_endpgm
L_v_done:
    v_add_u32 v4, 20480, v6
    s_mov_b32 s41, 3
    s_mov_b32 s86, 1
    s_mov_b32 s38, 15
    s_branch L_v_top
L_last:
L_end:
    s_endpgm
L_helper:
    v_and_b32 v0, 63, v0
    s_lshr_b32 s3, s2, 3
    s_lshl_b32 s3, s3, 12
    v_lshl_add_u32 v1, v0, 6, s3
    global_load_dword v20, v1, s[10:11]
    s_waitcnt vmcnt(0)
    global_load_dword v21, v1, s[12:13]
    s_waitcnt vmcnt(0)
    s_getpc_b64 s[56:57]
L_pc:
    s_sub_u32 s56, s56, L_pc-standalone__low_rank_proj_linformer__sampling_kernel
    s_subb_u32 s57, s57, 0
    s_lshr_b32 s3, s2, 3
    s_lshl_b32 s3, s3, 11
    v_lshl_add_u32 v1, v0, 5, s3
    v_min_u32 v1, L_codeend-standalone__low_rank_proj_linformer__sampling_kernel-4, v1
    global_load_dword v25, v1, s[56:57]
    s_waitcnt vmcnt(0)
    s_lshl_b32 s43, s30, 10
    s_add_u32 s28, s4, s43
    s_addc_u32 s29, s5, 0
    s_mov_b32 s30, 1024
    s_mov_b32 s31, 0x20000
    s_add_u32 s44, s14, s43
    s_addc_u32 s45, s15, 0
    s_mov_b32 s46, 1024
    s_mov_b32 s47, 0x20000
    v_lshrrev_b32 v4, 4, v0
    v_lshlrev_b32 v7, 8, v5
    v_lshl_add_u32 v7, v4, 6, v7
    v_lshlrev_b32 v6, 4, v0
    v_mov_b32 v2, v6
    v_mov_b32 v3, v6
    s_mov_b32 s48, 0x3db504f3
    s_mov_b32 s49, 0x3fb8aa3b
    s_mov_b32 s50, 0xffff0000
    v_xor_b32 v14, 16, v0
    v_lshlrev_b32 v14, 2, v14
    v_xor_b32 v15, 32, v0
    v_lshlrev_b32 v15, 2, v15
    s_mov_b32 s41, 0
    s_mov_b32 s30, 3072
    s_mov_b32 s3, 2048
    v_lshrrev_b32 v7, 2, v5
    v_lshlrev_b32 v7, 8, v7
    v_lshl_add_u32 v7, v4, 6, v7
    v_and_b32 v1, 3, v5
    v_cmp_eq_u32 vcc, 0, v1
    v_mov_b32 v1, 0x7fffffff
    s_nop 1
    v_cndmask_b32 v7, v1, v7, vcc
    buffer_load_dwordx4 v[48:51], v7, s[28:31], 0 offen offset:0 nt
    buffer_load_dwordx4 v[52:55], v7, s[28:31], 0 offen offset:16 nt
    buffer_load_dwordx4 v[56:59], v7, s[28:31], 0 offen offset:32 nt
    buffer_load_dwordx4 v[60:63], v7, s[28:31], 0 offen offset:48 nt
    buffer_load_dwordx4 v[96:99], v7, s[28:31], s3 offen offset:0 nt
    buffer_load_dwordx4 v[100:103], v7, s[28:31], s3 offen offset:16 nt
    buffer_load_dwordx4 v[104:107], v7, s[28:31], s3 offen offset:32 nt
    buffer_load_dwordx4 v[108:111], v7, s[28:31], s3 offen offset:48 nt
L_hbh:
    s_barrier
    ds_read_b128 v[16:19], v2 offset:0
    ds_read_b128 v[20:23], v2 offset:1024
    ds_read_b128 v[24:27], v2 offset:2048
    ds_read_b128 v[28:31], v2 offset:3072
    ds_read_b128 v[32:35], v2 offset:4096
    ds_read_b128 v[36:39], v2 offset:5120
    ds_read_b128 v[40:43], v2 offset:6144
    ds_read_b128 v[44:47], v2 offset:7168
    v_mov_b32 v8, 0
    v_mov_b32 v9, 0
    v_mov_b32 v10, 0
    v_mov_b32 v11, 0
    s_waitcnt lgkmcnt(0)
    v_cvt_pk_bf16_f32 v64, v16, v20
    v_cvt_pk_bf16_f32 v65, v24, v28
    v_cvt_pk_bf16_f32 v66, v32, v36
    v_cvt_pk_bf16_f32 v67, v40, v44
    v_cvt_pk_bf16_f32 v68, v17, v21
    v_cvt_pk_bf16_f32 v69, v25, v29
    v_cvt_pk_bf16_f32 v70, v33, v37
    v_cvt_pk_bf16_f32 v71, v41, v45
    v_cvt_pk_bf16_f32 v72, v18, v22
    v_cvt_pk_bf16_f32 v73, v26, v30
    v_cvt_pk_bf16_f32 v74, v34, v38
    v_cvt_pk_bf16_f32 v75, v42, v46
    v_cvt_pk_bf16_f32 v76, v19, v23
    v_cvt_pk_bf16_f32 v77, v27, v31
    v_cvt_pk_bf16_f32 v78, v35, v39
    v_cvt_pk_bf16_f32 v79, v43, v47
    s_waitcnt vmcnt(0)
    s_nop 0
    v_mfma_f32_16x16x32_bf16 v[8:11], v[64:67], v[48:51], v[8:11]
    v_mfma_f32_16x16x32_bf16 v[8:11], v[68:71], v[52:55], v[8:11]
    v_mfma_f32_16x16x32_bf16 v[8:11], v[72:75], v[56:59], v[8:11]
    v_mfma_f32_16x16x32_bf16 v[8:11], v[76:79], v[60:63], v[8:11]
    s_nop 7
    v_cvt_pk_bf16_f32 v12, v8, v9
    v_cvt_pk_bf16_f32 v13, v10, v11
    v_lshlrev_b32 v8, 16, v12
    v_and_b32 v9, s50, v12
    v_lshlrev_b32 v10, 16, v13
    v_and_b32 v11, s50, v13
    v_mul_f32 v8, s48, v8
    v_mul_f32 v9, s48, v9
    v_mul_f32 v10, s48, v10
    v_mul_f32 v11, s48, v11
    v_cvt_pk_bf16_f32 v12, v8, v9
    v_cvt_pk_bf16_f32 v13, v10, v11
    v_lshlrev_b32 v8, 16, v12
    v_and_b32 v9, s50, v12
    v_lshlrev_b32 v10, 16, v13
    v_and_b32 v11, s50, v13
    v_max_f32 v12, v8, v9
    v_max3_f32 v12, v10, v11, v12
    ds_bpermute_b32 v13, v14, v12
    s_waitcnt lgkmcnt(0)
    v_max_f32 v12, v12, v13
    ds_bpermute_b32 v13, v15, v12
    s_waitcnt lgkmcnt(0)
    v_max_f32 v12, v12, v13
    v_sub_f32 v8, v8, v12
    v_sub_f32 v9, v9, v12
    v_sub_f32 v10, v10, v12
    v_sub_f32 v11, v11, v12
    v_mul_f32 v8, s49, v8
    v_mul_f32 v9, s49, v9
    v_mul_f32 v10, s49, v10
    v_mul_f32 v11, s49, v11
    v_exp_f32 v8, v8
    v_exp_f32 v9, v9
    v_exp_f32 v10, v10
    v_exp_f32 v11, v11
    s_nop 0
    v_add_f32 v12, v8, v9
    v_add_f32 v13, v10, v11
    v_add_f32 v12, v12, v13
    ds_bpermute_b32 v13, v14, v12
    s_waitcnt lgkmcnt(0)
    v_add_f32 v12, v12, v13
    ds_bpermute_b32 v13, v15, v12
    s_waitcnt lgkmcnt(0)
    v_add_f32 v12, v12, v13
    v_rcp_f32 v12, v12
    s_nop 0
    v_mul_f32 v8, v8, v12
    v_mul_f32 v9, v9, v12
    v_mul_f32 v10, v10, v12
    v_mul_f32 v11, v11, v12
    v_cvt_pk_bf16_f32 v12, v8, v9
    v_cvt_pk_bf16_f32 v13, v10, v11
    ds_write_b64 v3, v[12:13] offset:16384
    v_add_u32 v3, 1024, v3
    v_add_u32 v2, 8192, v2
    v_mov_b64 v[48:49], v[96:97]
    v_mov_b64 v[50:51], v[98:99]
    v_mov_b64 v[52:53], v[100:101]
    v_mov_b64 v[54:55], v[102:103]
    v_mov_b64 v[56:57], v[104:105]
    v_mov_b64 v[58:59], v[106:107]
    v_mov_b64 v[60:61], v[108:109]
    v_mov_b64 v[62:63], v[110:111]
    s_add_u32 s28, s28, 2048
    s_addc_u32 s29, s29, 0
    s_add_u32 s41, s41, 1
    s_cmp_lt_u32 s41, 2
    s_cbranch_scc1 L_hbh
    s_waitcnt lgkmcnt(0)
    s_barrier
    ds_read_b64 v[4:5], v6 offset:16384
    ds_read_b128 v[16:19], v6 offset:20480
    ds_read_b128 v[20:23], v6 offset:21504
    ds_read_b128 v[24:27], v6 offset:22528
    ds_read_b128 v[28:31], v6 offset:23552
    ds_read_b128 v[32:35], v6 offset:24576
    ds_read_b128 v[36:39], v6 offset:25600
    ds_read_b128 v[40:43], v6 offset:26624
    ds_read_b128 v[44:47], v6 offset:27648
    v_cmp_gt_u32 vcc, 0x100, v6
    s_waitcnt lgkmcnt(0)
    v_cvt_pk_bf16_f32 v64, v16, v17
    v_cvt_pk_bf16_f32 v65, v18, v19
    v_cvt_pk_bf16_f32 v66, v20, v21
    v_cvt_pk_bf16_f32 v67, v22, v23
    v_cvt_pk_bf16_f32 v68, v24, v25
    v_cvt_pk_bf16_f32 v69, v26, v27
    v_cvt_pk_bf16_f32 v70, v28, v29
    v_cvt_pk_bf16_f32 v71, v30, v31
    v_cvt_pk_bf16_f32 v72, v32, v33
    v_cvt_pk_bf16_f32 v73, v34, v35
    v_cvt_pk_bf16_f32 v74, v36, v37
    v_cvt_pk_bf16_f32 v75, v38, v39
    v_cvt_pk_bf16_f32 v76, v40, v41
    v_cvt_pk_bf16_f32 v77, v42, v43
    v_cvt_pk_bf16_f32 v78, v44, v45
    v_cvt_pk_bf16_f32 v79, v46, v47
    s_waitcnt lgkmcnt(0)
    s_nop 0
    v_mfma_f32_16x16x16_bf16 v[16:19], v[4:5], v[64:65], 0
    v_mfma_f32_16x16x16_bf16 v[20:23], v[4:5], v[66:67], 0
    v_mfma_f32_16x16x16_bf16 v[24:27], v[4:5], v[68:69], 0
    v_mfma_f32_16x16x16_bf16 v[28:31], v[4:5], v[70:71], 0
    v_mfma_f32_16x16x16_bf16 v[32:35], v[4:5], v[72:73], 0
    v_mfma_f32_16x16x16_bf16 v[36:39], v[4:5], v[74:75], 0
    v_mfma_f32_16x16x16_bf16 v[40:43], v[4:5], v[76:77], 0
    v_mfma_f32_16x16x16_bf16 v[44:47], v[4:5], v[78:79], 0
    s_nop 7
    v_cvt_pk_bf16_f32 v80, v16, v20
    v_cvt_pk_bf16_f32 v81, v24, v28
    v_cvt_pk_bf16_f32 v82, v32, v36
    v_cvt_pk_bf16_f32 v83, v40, v44
    s_barrier
    buffer_store_dwordx4 v[80:83], v6, s[44:47], 0 offen
    s_endpgm
L_codeend:
.section .rodata,"a"
.p2align 6
.amdhsa_kernel standalone__low_rank_proj_linformer__sampling_kernel
  .amdhsa_next_free_vgpr 234
  .amdhsa_next_free_sgpr 102
  .amdhsa_accum_offset 236
  .amdhsa_group_segment_fixed_size 0
  .amdhsa_kernarg_size 64
  .amdhsa_user_sgpr_count 2
  .amdhsa_user_sgpr_kernarg_segment_ptr 1
  .amdhsa_system_sgpr_workgroup_id_x 1
  .amdhsa_float_denorm_mode_32 3
.end_amdhsa_kernel
```
